```python
import torch

def _softmax(x, axis=-1):
    return torch.softmax(x, dim=axis)
def _gelu(x):
    return torch.nn.functional.gelu(x, approximate="tanh")
def _silu(x):
    return torch.nn.functional.silu(x)
def _sigmoid(x):
    return torch.sigmoid(x)
def _layernorm(x, axis=-1, eps=1e-5):
    m = x.mean(dim=axis, keepdim=True)
    v = x.var(dim=axis, keepdim=True, unbiased=False)
    return (x - m) / torch.sqrt(v + eps)
def _scatter_add(tgt, idx, src, axis=0):
    return tgt.clone().index_add_(axis, idx, src)
def _segment_sum(src, seg, n):
    out = torch.zeros((n,) + src.shape[1:], dtype=src.dtype)
    return out.index_add_(0, seg, src)
def _pad(x, pw):
    flat = tuple(v for pair in reversed(pw) for v in pair)
    return torch.nn.functional.pad(x, flat)

kernel_name = 'gated_mix__ssm_conv_s4__geglu_ffn__prompt'

def setup_inputs():

    _w = (lambda a: (lambda t: t.to(torch.bfloat16) if t.is_floating_point() else t)(torch.as_tensor(a)))
    def _A_setup():
        B, L, D, N = 1, 2048, 512, 128
        A_re = -(lambda _x: torch.exp(torch.as_tensor(_x)))((lambda *s: torch.randn(*s, dtype=torch.bfloat16) * 6.4)(D, N))
        A_im = torch.pi * (lambda *s: torch.randn(*s, dtype=torch.bfloat16) * 0.05)(D, N)
        B_re = (lambda *s: torch.randn(*s, dtype=torch.bfloat16) * 0.1)(D, N)
        B_im = (lambda *s: torch.randn(*s, dtype=torch.bfloat16) * 0.1)(D, N)
        C_re = (lambda *s: torch.randn(*s, dtype=torch.bfloat16) * 0.1)(D, N)
        C_im = (lambda *s: torch.randn(*s, dtype=torch.bfloat16) * 0.1)(D, N)
        log_dt = (lambda *s: torch.randn(*s, dtype=torch.bfloat16) * 0.05)(D) * 0.5 - 4.0
        Dskip = (lambda *s: torch.randn(*s, dtype=torch.bfloat16) * 0.05)(D)
        return {
            "u": _w((lambda *s: torch.randn(*s, dtype=torch.bfloat16) * 0.05)(B, L, D)),
            "A_re": _w(A_re),
            "A_im": _w(A_im),
            "B_re": _w(B_re),
            "B_im": _w(B_im),
            "C_re": _w(C_re),
            "C_im": _w(C_im),
            "log_dt": _w(log_dt),
            "Dskip": _w(Dskip),
        }
    _A_in = _A_setup()

    def _B_setup():
        B, S, D, F = 1, 2048, 512, 1376
        return {
            "x": _w((lambda *s: torch.randn(*s, dtype=torch.bfloat16) * 0.05)(B, S, D)),
            "w_gate": _w((lambda *s: torch.randn(*s, dtype=torch.bfloat16) * 0.05)(D, F)),
            "w_up": _w((lambda *s: torch.randn(*s, dtype=torch.bfloat16) * 0.05)(D, F)),
            "w_down": _w((lambda *s: torch.randn(*s, dtype=torch.bfloat16) * 0.05)(F, D)),
        }
    _B_in = _B_setup()

    return {
        "A_u": _A_in["u"],
        "A_A_re": _A_in["A_re"],
        "A_A_im": _A_in["A_im"],
        "A_B_re": _A_in["B_re"],
        "A_B_im": _A_in["B_im"],
        "A_C_re": _A_in["C_re"],
        "A_C_im": _A_in["C_im"],
        "A_log_dt": _A_in["log_dt"],
        "A_Dskip": _A_in["Dskip"],
        "B_x": _B_in["x"],
        "B_w_gate": _B_in["w_gate"],
        "B_w_up": _B_in["w_up"],
        "B_w_down": _B_in["w_down"],
        "gate_w": _w((lambda *s: torch.randn(*s, dtype=torch.bfloat16) * 0.05)(512) * 16.0),
    }

def reference(A_u, A_A_re, A_A_im, A_B_re, A_B_im, A_C_re, A_C_im, A_log_dt, A_Dskip, B_x, B_w_gate, B_w_up, B_w_down, gate_w):
    def _A_ref(u, A_re, A_im, B_re, B_im, C_re, C_im, log_dt, Dskip):
        Bsz, L, D = u.shape
        dt = torch.exp(log_dt)[:, None]
        A = A_re + 1j * A_im
        Bc = B_re + 1j * B_im
        Cc = C_re + 1j * C_im
        logdA = dt * A
        dB = dt * Bc
        l = (lambda x, dt: x.to(dt))(torch.arange(L), A_re.dtype)
        P = torch.exp(logdA[:, :, None] * l[None, None, :])
        K = torch.einsum("dn,dnl,dn->dl", Cc, P, dB).real
        L2 = 2 * L
        Kp = _pad(K, ((0, 0), (0, L)))
        up = (lambda x, *d: x.permute(*d))(u, 0, 2, 1)
        up = _pad(up, ((0, 0), (0, 0), (0, L)))
        Kf = (lambda x, axes=(-2,-1): torch.fft.rfft2(x.float(), dim=axes))(Kp[:, None, :], axes=(-2, -1))
        Uf = (lambda x, axes=(-2,-1): torch.fft.rfft2(x.float(), dim=axes))(up[:, :, None, :], axes=(-2, -1))
        Yf = Uf * Kf[None, :, :, :]
        y = (lambda x, s, axes=(-2,-1): torch.fft.irfft2(x, s=s, dim=axes).to(torch.bfloat16))(Yf, (1, L2), axes=(-2, -1))[:, :, 0, :L]
        y = (lambda x, *d: x.permute(*d))(y, 0, 2, 1) + u * Dskip[None, None, :]
        return y

    def _B_ref(x, w_gate, w_up, w_down):
        return (_gelu(x @ w_gate) * (x @ w_up)) @ w_down

    x = A_u
    g = _sigmoid((x * gate_w).sum(-1, keepdims=True))
    a = _A_ref(x, A_A_re, A_A_im, A_B_re, A_B_im, A_C_re, A_C_im, A_log_dt, A_Dskip)
    b = _B_ref(x, B_w_gate, B_w_up, B_w_down)
    return g * a + (1 - g) * b
```

```asm
; @launch kernel=k1_kernel grid=(512,1,1) block=(256,1,1) lds=81920
.amdgcn_target "amdgcn-amd-amdhsa--gfx950"
.text
.globl k1_kernel
.p2align 8
.type k1_kernel,@function
k1_kernel:
    s_cmp_ge_u32 s2, 256
    s_cbranch_scc1 Lk1_b
    s_setprio 3
    s_load_dwordx16 s[16:31], s[0:1], 0
    s_load_dwordx2 s[32:33], s[0:1], 96
    s_load_dwordx4 s[36:39], s[0:1], 120
    s_load_dwordx2 s[56:57], s[0:1], 64
    s_memrealtime s[60:61]
    v_lshrrev_b32 v1, 6, v0
    v_and_b32 v2, 63, v0
    v_readfirstlane_b32 s3, v1
    s_lshr_b32 s8, s2, 3
    s_and_b32 s9, s2, 7
    s_lshl_b32 s4, s9, 5
    s_add_u32 s4, s4, s8
    s_lshl_b32 s63, s4, 3
    s_lshl_b32 s5, s4, 9
    v_lshrrev_b32 v3, 1, v0
    v_lshl_add_u32 v3, v3, 2, s5
    s_lshl_b32 s7, s4, 2
    s_lshr_b32 s5, s3, 1
    v_and_b32 v5, 31, v2
    v_lshrrev_b32 v6, 5, v2
    s_lshl_b32 s11, s8, 16
    s_lshl_b32 s12, s9, 7
    s_add_u32 s11, s11, s12
    s_lshl_b32 s10, s3, 5
    s_add_u32 s11, s11, s10
    s_add_u32 s11, s11, 4096
    v_and_b32 v124, 7, v2
    v_lshrrev_b32 v125, 3, v2
    v_lshlrev_b32 v7, 13, v124
    v_lshl_add_u32 v7, v125, 2, v7
    v_add_u32 v7, s11, v7
    s_lshl_b32 s13, s2, 2
    s_add_u32 s13, s13, s3
    s_lshl_b32 s10, s8, 2
    s_add_u32 s10, s10, s3
    s_lshl_b32 s40, s10, 14
    s_add_u32 s40, s40, s12
    v_lshlrev_b32 v8, 10, v125
    v_lshl_add_u32 v8, v124, 4, v8
    v_add_u32 v8, s40, v8
    v_add_u32 v9, 0x2000, v8
    v_lshlrev_b32 v10, 4, v2
    v_mov_b32 v23, 0
    s_waitcnt lgkmcnt(0)
    s_add_u32 s63, s63, 13549568
    s_mov_b32 s40, s32
    s_mov_b32 s41, s33
    s_mov_b32 s42, 0x158000
    s_mov_b32 s43, 0x00020000
    s_mov_b32 s48, s38
    s_mov_b32 s49, s39
    s_mov_b32 s50, 0xd70000
    s_mov_b32 s51, 0x00020000
    s_cmp_lg_u32 s13, 0
    s_cbranch_scc1 Lb_notag
    s_or_b32 s60, s60, 1
    v_mov_b32 v14, s60
    v_mov_b32 v15, s61
    s_mov_b64 exec, 1
    global_store_dwordx2 v23, v[14:15], s[36:37] sc1
    s_mov_b64 exec, -1
Lb_notag:
    global_load_dword v32, v7, s[16:17] offset:-4096
    global_load_dword v33, v7, s[16:17] offset:-3072
    global_load_dword v34, v7, s[16:17] offset:-2048
    global_load_dword v35, v7, s[16:17] offset:-1024
    global_load_dword v36, v7, s[16:17] offset:0
    global_load_dword v37, v7, s[16:17] offset:1024
    global_load_dword v38, v7, s[16:17] offset:2048
    global_load_dword v39, v7, s[16:17] offset:3072
    global_load_dword v16, v3, s[18:19]
    global_load_dword v17, v3, s[20:21]
    global_load_dword v18, v3, s[22:23]
    global_load_dword v19, v3, s[24:25]
    global_load_dword v20, v3, s[26:27]
    global_load_dword v21, v3, s[28:29]
    s_load_dword s58, s[30:31], s7
    s_load_dword s59, s[56:57], s7
    s_lshl_b32 s15, s3, 11
    s_mov_b32 m0, s15
    s_nop 0
    buffer_load_dwordx4 v8, s[40:43], 0 offen lds
    s_add_u32 m0, s15, 1024
    s_nop 0
    buffer_load_dwordx4 v9, s[40:43], 0 offen lds
    s_setprio 0
    v_and_b32 v12, 15, v2
    v_and_b32 v13, 7, v12
    v_lshrrev_b32 v14, 3, v12
    v_lshl_add_u32 v60, v14, 7, v13
    v_lshrrev_b32 v14, 2, v12
    v_lshlrev_b32 v14, 7, v14
    v_and_b32 v15, 3, v12
    v_lshl_add_u32 v14, v15, 1, v14
    v_add_u32 v14, 0x100, v14
    v_lshrrev_b32 v15, 1, v13
    v_lshlrev_b32 v15, 7, v15
    v_and_b32 v61, 1, v12
    v_lshl_add_u32 v15, v61, 2, v15
    v_add_u32 v15, 0x200, v15
    v_cmp_gt_u32 vcc, 8, v12
    s_nop 1
    v_cndmask_b32 v61, v15, v14, vcc
    s_and_b32 s6, s3, 1
    s_cmp_eq_u32 s6, 0
    s_cselect_b64 vcc, -1, 0
    v_cndmask_b32 v60, v61, v60, vcc
    v_min_u32 v67, 8, v12
    v_lshlrev_b32 v62, 7, v67
    v_add_u32 v62, 0x400, v62
    v_lshrrev_b32 v13, 4, v2
    v_lshlrev_b32 v14, 5, v13
    v_add_u32 v14, v14, v6
    v_lshrrev_b32 v15, 6, v60
    v_add3_u32 v60, v60, v15, v14
    v_lshrrev_b32 v15, 6, v62
    v_add3_u32 v62, v62, v15, v14
    s_mul_i32 s44, s5, 8960
    v_lshl_add_u32 v60, v60, 2, s44
    v_lshl_add_u32 v62, v62, 2, s44
    s_mul_i32 s44, s3, 15504
    s_add_u32 s44, s44, 17920
    v_lshl_add_u32 v63, v2, 2, s44
    s_mul_i32 s44, s5, 31008
    s_add_u32 s44, s44, 17920
    v_lshl_add_u32 v14, v13, 4, s44
    v_mul_u32_u24 v15, 272, v12
    v_add_u32 v64, v14, v15
    s_mul_i32 s44, s6, 4352
    v_add_u32 v65, s44, v64
    v_mul_u32_u24 v15, 272, v67
    v_add_u32 v66, v14, v15
    s_mov_b32 s52, 0x05040100
    s_mov_b32 s53, 0x07060302
    s_mov_b32 s54, 0xffff0000
    v_lshlrev_b32 v14, 5, v0
    v_sub_u32 v14, 8188, v14
    v_subrev_u32 v128, 0, v14
    v_max_i32 v128, 0, v128
    v_cvt_f32_u32 v128, v128
    v_subrev_u32 v129, 4, v14
    v_max_i32 v129, 0, v129
    v_cvt_f32_u32 v129, v129
    v_subrev_u32 v130, 8, v14
    v_max_i32 v130, 0, v130
    v_cvt_f32_u32 v130, v130
    v_subrev_u32 v131, 12, v14
    v_max_i32 v131, 0, v131
    v_cvt_f32_u32 v131, v131
    v_subrev_u32 v132, 16, v14
    v_max_i32 v132, 0, v132
    v_cvt_f32_u32 v132, v132
    v_subrev_u32 v133, 20, v14
    v_max_i32 v133, 0, v133
    v_cvt_f32_u32 v133, v133
    v_subrev_u32 v134, 24, v14
    v_max_i32 v134, 0, v134
    v_cvt_f32_u32 v134, v134
    v_subrev_u32 v135, 28, v14
    v_max_i32 v135, 0, v135
    v_cvt_f32_u32 v135, v135
    v_subrev_u32 v136, 32, v14
    v_max_i32 v136, 0, v136
    v_cvt_f32_u32 v136, v136
    v_subrev_u32 v137, 36, v14
    v_max_i32 v137, 0, v137
    v_cvt_f32_u32 v137, v137
    v_subrev_u32 v138, 40, v14
    v_max_i32 v138, 0, v138
    v_cvt_f32_u32 v138, v138
    v_subrev_u32 v139, 44, v14
    v_max_i32 v139, 0, v139
    v_cvt_f32_u32 v139, v139
    v_cvt_pk_bf16_f32 v128, v128, v129
    v_and_b32 v129, s54, v128
    v_lshlrev_b32 v128, 16, v128
    v_cvt_u32_f32 v129, v129
    v_cvt_u32_f32 v128, v128
    v_lshrrev_b32 v14, 8, v129
    v_lshrrev_b32 v15, 8, v128
    v_lshl_add_u32 v129, v14, 2, v129
    v_lshl_add_u32 v128, v15, 2, v128
    v_cvt_pk_bf16_f32 v130, v130, v131
    v_and_b32 v131, s54, v130
    v_lshlrev_b32 v130, 16, v130
    v_cvt_u32_f32 v131, v131
    v_cvt_u32_f32 v130, v130
    v_lshrrev_b32 v14, 8, v131
    v_lshrrev_b32 v15, 8, v130
    v_lshl_add_u32 v131, v14, 2, v131
    v_lshl_add_u32 v130, v15, 2, v130
    v_cvt_pk_bf16_f32 v132, v132, v133
    v_and_b32 v133, s54, v132
    v_lshlrev_b32 v132, 16, v132
    v_cvt_u32_f32 v133, v133
    v_cvt_u32_f32 v132, v132
    v_lshrrev_b32 v14, 8, v133
    v_lshrrev_b32 v15, 8, v132
    v_lshl_add_u32 v133, v14, 2, v133
    v_lshl_add_u32 v132, v15, 2, v132
    v_cvt_pk_bf16_f32 v134, v134, v135
    v_and_b32 v135, s54, v134
    v_lshlrev_b32 v134, 16, v134
    v_cvt_u32_f32 v135, v135
    v_cvt_u32_f32 v134, v134
    v_lshrrev_b32 v14, 8, v135
    v_lshrrev_b32 v15, 8, v134
    v_lshl_add_u32 v135, v14, 2, v135
    v_lshl_add_u32 v134, v15, 2, v134
    v_cvt_pk_bf16_f32 v136, v136, v137
    v_and_b32 v137, s54, v136
    v_lshlrev_b32 v136, 16, v136
    v_cvt_u32_f32 v137, v137
    v_cvt_u32_f32 v136, v136
    v_lshrrev_b32 v14, 8, v137
    v_lshrrev_b32 v15, 8, v136
    v_lshl_add_u32 v137, v14, 2, v137
    v_lshl_add_u32 v136, v15, 2, v136
    v_cvt_pk_bf16_f32 v138, v138, v139
    v_and_b32 v139, s54, v138
    v_lshlrev_b32 v138, 16, v138
    v_cvt_u32_f32 v139, v139
    v_cvt_u32_f32 v138, v138
    v_lshrrev_b32 v14, 8, v139
    v_lshrrev_b32 v15, 8, v138
    v_lshl_add_u32 v139, v14, 2, v139
    v_lshl_add_u32 v138, v15, 2, v138
    v_and_b32 v68, 15, v2
    v_lshrrev_b32 v69, 4, v2
    v_sub_u32 v70, 3, v68
    v_and_b32 v70, 3, v70
    v_sub_u32 v71, 2031, v68
    v_lshl_add_u32 v71, v69, 3, v71
    v_sub_u32 v71, v71, v70
    v_lshlrev_b32 v71, 1, v71
    v_mul_u32_u24 v70, 4160, v70
    v_add_u32 v71, v71, v70
    s_mul_i32 s12, s5, 21248
    s_add_u32 s12, s12, 17920
    s_lshl_b32 s44, s6, 8
    s_sub_u32 s44, s12, s44
    s_sub_u32 s45, s44, 3776
    v_add_u32 v120, s45, v71
    v_lshlrev_b32 v70, 5, v68
    v_lshl_add_u32 v121, v69, 4, v70
    s_add_u32 s45, s44, 16928
    v_add_u32 v121, s45, v121
    v_lshl_add_u32 v122, v69, 3, v70
    v_and_b32 v68, 31, v0
    v_lshlrev_b32 v123, 4, v68
    v_add_u32 v123, 16640, v123
    v_bfe_u32 v70, v0, 5, 1
    v_mul_u32_u24 v70, 21248, v70
    v_add_u32 v123, v123, v70
    v_and_b32 v70, 3, v0
    v_lshlrev_b32 v70, 4, v70
    v_bfe_u32 v71, v0, 2, 2
    v_mul_u32_u24 v71, 4160, v71
    v_add_u32 v70, v70, v71
    v_bfe_u32 v71, v0, 4, 1
    v_mul_u32_u24 v71, 21248, v71
    v_add_u32 v70, v70, v71
    v_add_u32 v70, 0x1000, v70
    v_cmp_gt_u32 vcc, 64, v0
    s_nop 1
    v_cndmask_b32 v123, v70, v123, vcc
    v_mov_b32 v52, 0
    v_mov_b32 v53, 0
    v_mov_b32 v54, 0
    v_mov_b32 v55, 0
    s_lshl_b32 s44, s9, 2
    s_lshr_b32 s45, s8, 3
    s_add_u32 s45, s45, s44
    s_lshl_b32 s45, s45, 7
    s_add_u32 s14, s45, 13508608
    v_lshl_add_u32 v126, v5, 2, s14
    s_add_u32 s55, s44, s3
    s_lshl_b32 s55, s55, 5
    s_add_u32 s55, s55, s8
    s_lshl_b32 s55, s55, 2
    s_add_u32 s55, s55, 13508608
    s_lshl_b32 s44, s9, 18
    s_lshl_b32 s45, s8, 7
    s_add_u32 s44, s44, s45
    s_lshl_b32 s45, s3, 16
    s_add_u32 s44, s44, s45
    s_add_u32 s44, s44, 7208960
    v_lshlrev_b32 v7, 13, v125
    v_lshl_add_u32 v7, v124, 4, v7
    v_add_u32 v127, 0x1000, v7
    v_bfe_u32 v8, v2, 2, 2
    v_lshl_add_u32 v8, v6, 2, v8
    v_lshlrev_b32 v8, 7, v8
    v_bfe_u32 v9, v2, 4, 1
    v_lshl_add_u32 v8, v9, 5, v8
    v_and_b32 v9, 3, v2
    v_lshl_add_u32 v8, v9, 3, v8
    v_add_u32 v8, s15, v8
    s_mul_i32 s45, s9, 176
    s_add_u32 s45, s45, s10
    s_lshl_b32 s45, s45, 10
    s_add_u32 s45, s45, 5767168
    s_add_u32 s46, s45, 90112
    s_lshl_b32 s11, s9, 7
    s_add_u32 s11, s11, s10
    s_lshl_b32 s11, s11, 2
    s_add_u32 s11, s11, 13553664
    v_and_b32 v9, 1, v2
    v_xor_b32 v9, 1, v9
    v_lshlrev_b32 v9, 4, v9
    s_waitcnt lgkmcnt(0)
    s_lshl_b32 s15, s5, 4
    s_lshr_b32 s58, s58, s15
    s_lshl_b32 s58, s58, 16
    s_lshr_b32 s59, s59, s15
    s_lshl_b32 s59, s59, 16
    v_mov_b32 v5, s59
    v_mov_b32 v22, s58
    v_mul_f32 v22, 0x3fb8aa3b, v22
    v_exp_f32 v22, v22
    s_waitcnt vmcnt(2)
    v_perm_b32 v140, v33, v32, s52
    v_perm_b32 v141, v35, v34, s52
    v_perm_b32 v142, v37, v36, s52
    v_perm_b32 v143, v39, v38, s52
    v_perm_b32 v144, v33, v32, s53
    v_perm_b32 v145, v35, v34, s53
    v_perm_b32 v146, v37, v36, s53
    v_perm_b32 v147, v39, v38, s53
    s_setprio 3
    buffer_store_dwordx4 v[140:143], v7, s[48:51], s44 offen sc1
    buffer_store_dwordx4 v[144:147], v127, s[48:51], s44 offen sc1
    global_load_dwordx2 v[156:157], v23, s[36:37]
    s_setprio 0
    v_lshlrev_b32 v16, v9, v16
    v_and_b32 v16, s54, v16
    v_lshlrev_b32 v17, v9, v17
    v_and_b32 v17, s54, v17
    v_lshlrev_b32 v18, v9, v18
    v_and_b32 v18, s54, v18
    v_lshlrev_b32 v19, v9, v19
    v_and_b32 v19, s54, v19
    v_lshlrev_b32 v20, v9, v20
    v_and_b32 v20, s54, v20
    v_lshlrev_b32 v21, v9, v21
    v_and_b32 v21, s54, v21
    v_cvt_pk_bf16_f32 v22, v22, v22
    v_lshlrev_b32 v22, 16, v22
    v_mul_f32 v16, v16, v22
    v_mul_f32 v17, v17, v22
    v_mul_f32 v18, v18, v22
    v_mul_f32 v19, v19, v22
    v_mul_f32 v24, 0x3fb8aa3b, v16
    v_mul_f32 v27, 0.15915494, v17
    v_mul_f32 v25, 0x41000000, v24
    v_mul_f32 v26, 0x43000000, v24
    v_mul_f32 v28, 0x41000000, v27
    v_mul_f32 v29, 0x43000000, v27
    v_fract_f32 v27, v27
    v_fract_f32 v28, v28
    v_fract_f32 v29, v29
    v_exp_f32 v24, v24
    v_cos_f32 v82, v27
    v_sin_f32 v83, v27
    v_exp_f32 v25, v25
    v_cos_f32 v96, v28
    v_sin_f32 v97, v28
    v_exp_f32 v26, v26
    v_cos_f32 v98, v29
    v_sin_f32 v99, v29
    v_mul_f32 v100, v20, v18
    v_fma_f32 v100, -v21, v19, v100
    v_mul_f32 v101, v20, v19
    v_fma_f32 v101, -v21, v18, -v101
    v_mul_f32 v82, v82, v24
    v_mul_f32 v83, v83, v24
    v_mul_f32 v96, v96, v25
    v_mul_f32 v97, -v97, v25
    v_mul_f32 v98, v98, v26
    v_mul_f32 v99, v99, v26
    v_mov_b32 v112, 0x3f80
    ds_write_b32 v63, v112 offset:4352
    v_cvt_pk_bf16_f32 v113, v82, v83
    ds_write_b32 v63, v113 offset:4624
    v_cvt_pk_bf16_f32 v114, v100, v101
    v_pk_mul_f32 v[84:85], v[82:83], v[82:83] op_sel:[0,0] op_sel_hi:[0,1]
    v_pk_fma_f32 v[84:85], v[82:83], v[82:83], v[84:85] op_sel:[1,1,0] op_sel_hi:[1,0,1] neg_lo:[1,0,0]
    ds_write_b32 v63, v114 offset:0
    v_cvt_pk_bf16_f32 v115, v84, v85
    ds_write_b32 v63, v115 offset:4896
    v_pk_mul_f32 v[102:103], v[100:101], v[96:97] op_sel:[0,0] op_sel_hi:[0,1]
    v_pk_mul_f32 v[86:87], v[82:83], v[84:85] op_sel:[0,0] op_sel_hi:[0,1]
    v_pk_fma_f32 v[86:87], v[82:83], v[84:85], v[86:87] op_sel:[1,1,0] op_sel_hi:[1,0,1] neg_lo:[1,0,0]
    v_pk_fma_f32 v[102:103], v[100:101], v[96:97], v[102:103] op_sel:[1,1,0] op_sel_hi:[1,0,1] neg_lo:[1,0,0]
    v_cvt_pk_bf16_f32 v116, v86, v87
    ds_write_b32 v63, v116 offset:5168
    v_cvt_pk_bf16_f32 v117, v102, v103
    v_pk_mul_f32 v[88:89], v[84:85], v[84:85] op_sel:[0,0] op_sel_hi:[0,1]
    v_pk_fma_f32 v[88:89], v[84:85], v[84:85], v[88:89] op_sel:[1,1,0] op_sel_hi:[1,0,1] neg_lo:[1,0,0]
    ds_write_b32 v63, v117 offset:272
    v_cvt_pk_bf16_f32 v118, v88, v89
    ds_write_b32 v63, v118 offset:5440
    v_pk_mul_f32 v[100:101], v[102:103], v[96:97] op_sel:[0,0] op_sel_hi:[0,1]
    v_pk_mul_f32 v[90:91], v[84:85], v[86:87] op_sel:[0,0] op_sel_hi:[0,1]
    v_pk_fma_f32 v[90:91], v[84:85], v[86:87], v[90:91] op_sel:[1,1,0] op_sel_hi:[1,0,1] neg_lo:[1,0,0]
    v_pk_fma_f32 v[100:101], v[102:103], v[96:97], v[100:101] op_sel:[1,1,0] op_sel_hi:[1,0,1] neg_lo:[1,0,0]
    v_cvt_pk_bf16_f32 v119, v90, v91
    ds_write_b32 v63, v119 offset:5712
    v_cvt_pk_bf16_f32 v113, v100, v101
    v_pk_mul_f32 v[92:93], v[86:87], v[86:87] op_sel:[0,0] op_sel_hi:[0,1]
    v_pk_fma_f32 v[92:93], v[86:87], v[86:87], v[92:93] op_sel:[1,1,0] op_sel_hi:[1,0,1] neg_lo:[1,0,0]
    ds_write_b32 v63, v113 offset:544
    v_cvt_pk_bf16_f32 v114, v92, v93
    ds_write_b32 v63, v114 offset:5984
    v_pk_mul_f32 v[102:103], v[100:101], v[96:97] op_sel:[0,0] op_sel_hi:[0,1]
    v_pk_mul_f32 v[94:95], v[86:87], v[88:89] op_sel:[0,0] op_sel_hi:[0,1]
    v_pk_fma_f32 v[94:95], v[86:87], v[88:89], v[94:95] op_sel:[1,1,0] op_sel_hi:[1,0,1] neg_lo:[1,0,0]
    v_pk_fma_f32 v[102:103], v[100:101], v[96:97], v[102:103] op_sel:[1,1,0] op_sel_hi:[1,0,1] neg_lo:[1,0,0]
    v_cvt_pk_bf16_f32 v115, v94, v95
    ds_write_b32 v63, v115 offset:6256
    v_cvt_pk_bf16_f32 v116, v102, v103
    v_cvt_pk_bf16_f32 v117, v98, v99
    ds_write_b32 v63, v117 offset:6528
    ds_write_b32 v63, v116 offset:816
    v_pk_mul_f32 v[108:109], v[98:99], v[82:83] op_sel:[0,0] op_sel_hi:[0,1]
    v_pk_fma_f32 v[108:109], v[98:99], v[82:83], v[108:109] op_sel:[1,1,0] op_sel_hi:[1,0,1] neg_lo:[1,0,0]
    v_pk_mul_f32 v[100:101], v[102:103], v[96:97] op_sel:[0,0] op_sel_hi:[0,1]
    v_cvt_pk_bf16_f32 v118, v108, v109
    ds_write_b32 v63, v118 offset:6800
    v_pk_fma_f32 v[100:101], v[102:103], v[96:97], v[100:101] op_sel:[1,1,0] op_sel_hi:[1,0,1] neg_lo:[1,0,0]
    v_pk_mul_f32 v[110:111], v[98:99], v[84:85] op_sel:[0,0] op_sel_hi:[0,1]
    v_pk_fma_f32 v[110:111], v[98:99], v[84:85], v[110:111] op_sel:[1,1,0] op_sel_hi:[1,0,1] neg_lo:[1,0,0]
    v_cvt_pk_bf16_f32 v119, v100, v101
    v_cvt_pk_bf16_f32 v113, v110, v111
    ds_write_b32 v63, v113 offset:7072
    ds_write_b32 v63, v119 offset:1088
    v_pk_mul_f32 v[108:109], v[98:99], v[86:87] op_sel:[0,0] op_sel_hi:[0,1]
    v_pk_fma_f32 v[108:109], v[98:99], v[86:87], v[108:109] op_sel:[1,1,0] op_sel_hi:[1,0,1] neg_lo:[1,0,0]
    v_pk_mul_f32 v[102:103], v[100:101], v[96:97] op_sel:[0,0] op_sel_hi:[0,1]
    v_cvt_pk_bf16_f32 v114, v108, v109
    ds_write_b32 v63, v114 offset:7344
    v_pk_fma_f32 v[102:103], v[100:101], v[96:97], v[102:103] op_sel:[1,1,0] op_sel_hi:[1,0,1] neg_lo:[1,0,0]
    v_pk_mul_f32 v[110:111], v[98:99], v[88:89] op_sel:[0,0] op_sel_hi:[0,1]
    v_pk_fma_f32 v[110:111], v[98:99], v[88:89], v[110:111] op_sel:[1,1,0] op_sel_hi:[1,0,1] neg_lo:[1,0,0]
    v_cvt_pk_bf16_f32 v115, v102, v103
    v_cvt_pk_bf16_f32 v116, v110, v111
    ds_write_b32 v63, v116 offset:7616
    ds_write_b32 v63, v115 offset:1360
    v_pk_mul_f32 v[108:109], v[98:99], v[90:91] op_sel:[0,0] op_sel_hi:[0,1]
    v_pk_fma_f32 v[108:109], v[98:99], v[90:91], v[108:109] op_sel:[1,1,0] op_sel_hi:[1,0,1] neg_lo:[1,0,0]
    v_pk_mul_f32 v[100:101], v[102:103], v[96:97] op_sel:[0,0] op_sel_hi:[0,1]
    v_cvt_pk_bf16_f32 v117, v108, v109
    ds_write_b32 v63, v117 offset:7888
    v_pk_fma_f32 v[100:101], v[102:103], v[96:97], v[100:101] op_sel:[1,1,0] op_sel_hi:[1,0,1] neg_lo:[1,0,0]
    v_pk_mul_f32 v[110:111], v[98:99], v[92:93] op_sel:[0,0] op_sel_hi:[0,1]
    v_pk_fma_f32 v[110:111], v[98:99], v[92:93], v[110:111] op_sel:[1,1,0] op_sel_hi:[1,0,1] neg_lo:[1,0,0]
    v_cvt_pk_bf16_f32 v118, v100, v101
    v_cvt_pk_bf16_f32 v119, v110, v111
    ds_write_b32 v63, v119 offset:8160
    ds_write_b32 v63, v118 offset:1632
    v_pk_mul_f32 v[108:109], v[98:99], v[94:95] op_sel:[0,0] op_sel_hi:[0,1]
    v_pk_fma_f32 v[108:109], v[98:99], v[94:95], v[108:109] op_sel:[1,1,0] op_sel_hi:[1,0,1] neg_lo:[1,0,0]
    v_pk_mul_f32 v[102:103], v[100:101], v[96:97] op_sel:[0,0] op_sel_hi:[0,1]
    v_cvt_pk_bf16_f32 v113, v108, v109
    ds_write_b32 v63, v113 offset:8432
    v_pk_fma_f32 v[102:103], v[100:101], v[96:97], v[102:103] op_sel:[1,1,0] op_sel_hi:[1,0,1] neg_lo:[1,0,0]
    v_pk_mul_f32 v[104:105], v[98:99], v[98:99] op_sel:[0,0] op_sel_hi:[0,1]
    v_pk_fma_f32 v[104:105], v[98:99], v[98:99], v[104:105] op_sel:[1,1,0] op_sel_hi:[1,0,1] neg_lo:[1,0,0]
    v_cvt_pk_bf16_f32 v114, v102, v103
    v_cvt_pk_bf16_f32 v115, v104, v105
    ds_write_b32 v63, v115 offset:8704
    ds_write_b32 v63, v114 offset:1904
    v_pk_mul_f32 v[110:111], v[104:105], v[84:85] op_sel:[0,0] op_sel_hi:[0,1]
    v_pk_fma_f32 v[110:111], v[104:105], v[84:85], v[110:111] op_sel:[1,1,0] op_sel_hi:[1,0,1] neg_lo:[1,0,0]
    v_pk_mul_f32 v[100:101], v[102:103], v[96:97] op_sel:[0,0] op_sel_hi:[0,1]
    v_cvt_pk_bf16_f32 v116, v110, v111
    ds_write_b32 v63, v116 offset:8976
    v_pk_fma_f32 v[100:101], v[102:103], v[96:97], v[100:101] op_sel:[1,1,0] op_sel_hi:[1,0,1] neg_lo:[1,0,0]
    v_pk_mul_f32 v[108:109], v[104:105], v[88:89] op_sel:[0,0] op_sel_hi:[0,1]
    v_pk_fma_f32 v[108:109], v[104:105], v[88:89], v[108:109] op_sel:[1,1,0] op_sel_hi:[1,0,1] neg_lo:[1,0,0]
    v_cvt_pk_bf16_f32 v117, v100, v101
    v_cvt_pk_bf16_f32 v118, v108, v109
    ds_write_b32 v63, v118 offset:9248
    ds_write_b32 v63, v117 offset:2176
    v_pk_mul_f32 v[110:111], v[104:105], v[92:93] op_sel:[0,0] op_sel_hi:[0,1]
    v_pk_fma_f32 v[110:111], v[104:105], v[92:93], v[110:111] op_sel:[1,1,0] op_sel_hi:[1,0,1] neg_lo:[1,0,0]
    v_pk_mul_f32 v[102:103], v[100:101], v[96:97] op_sel:[0,0] op_sel_hi:[0,1]
    v_cvt_pk_bf16_f32 v119, v110, v111
    ds_write_b32 v63, v119 offset:9520
    v_pk_fma_f32 v[102:103], v[100:101], v[96:97], v[102:103] op_sel:[1,1,0] op_sel_hi:[1,0,1] neg_lo:[1,0,0]
    v_pk_mul_f32 v[106:107], v[104:105], v[98:99] op_sel:[0,0] op_sel_hi:[0,1]
    v_pk_fma_f32 v[106:107], v[104:105], v[98:99], v[106:107] op_sel:[1,1,0] op_sel_hi:[1,0,1] neg_lo:[1,0,0]
    v_cvt_pk_bf16_f32 v113, v102, v103
    v_cvt_pk_bf16_f32 v114, v106, v107
    ds_write_b32 v63, v114 offset:9792
    ds_write_b32 v63, v113 offset:2448
    v_pk_mul_f32 v[108:109], v[106:107], v[84:85] op_sel:[0,0] op_sel_hi:[0,1]
    v_pk_fma_f32 v[108:109], v[106:107], v[84:85], v[108:109] op_sel:[1,1,0] op_sel_hi:[1,0,1] neg_lo:[1,0,0]
    v_pk_mul_f32 v[100:101], v[102:103], v[96:97] op_sel:[0,0] op_sel_hi:[0,1]
    v_cvt_pk_bf16_f32 v115, v108, v109
    ds_write_b32 v63, v115 offset:10064
    v_pk_fma_f32 v[100:101], v[102:103], v[96:97], v[100:101] op_sel:[1,1,0] op_sel_hi:[1,0,1] neg_lo:[1,0,0]
    v_pk_mul_f32 v[110:111], v[106:107], v[88:89] op_sel:[0,0] op_sel_hi:[0,1]
    v_pk_fma_f32 v[110:111], v[106:107], v[88:89], v[110:111] op_sel:[1,1,0] op_sel_hi:[1,0,1] neg_lo:[1,0,0]
    v_cvt_pk_bf16_f32 v116, v100, v101
    v_cvt_pk_bf16_f32 v117, v110, v111
    ds_write_b32 v63, v117 offset:10336
    ds_write_b32 v63, v116 offset:2720
    v_pk_mul_f32 v[108:109], v[106:107], v[92:93] op_sel:[0,0] op_sel_hi:[0,1]
    v_pk_fma_f32 v[108:109], v[106:107], v[92:93], v[108:109] op_sel:[1,1,0] op_sel_hi:[1,0,1] neg_lo:[1,0,0]
    v_pk_mul_f32 v[102:103], v[100:101], v[96:97] op_sel:[0,0] op_sel_hi:[0,1]
    v_cvt_pk_bf16_f32 v118, v108, v109
    ds_write_b32 v63, v118 offset:10608
    v_pk_fma_f32 v[102:103], v[100:101], v[96:97], v[102:103] op_sel:[1,1,0] op_sel_hi:[1,0,1] neg_lo:[1,0,0]
    v_pk_mul_f32 v[104:105], v[106:107], v[98:99] op_sel:[0,0] op_sel_hi:[0,1]
    v_pk_fma_f32 v[104:105], v[106:107], v[98:99], v[104:105] op_sel:[1,1,0] op_sel_hi:[1,0,1] neg_lo:[1,0,0]
    v_cvt_pk_bf16_f32 v119, v102, v103
    v_cvt_pk_bf16_f32 v113, v104, v105
    ds_write_b32 v63, v113 offset:10880
    ds_write_b32 v63, v119 offset:2992
    v_pk_mul_f32 v[110:111], v[104:105], v[88:89] op_sel:[0,0] op_sel_hi:[0,1]
    v_pk_fma_f32 v[110:111], v[104:105], v[88:89], v[110:111] op_sel:[1,1,0] op_sel_hi:[1,0,1] neg_lo:[1,0,0]
    v_pk_mul_f32 v[100:101], v[102:103], v[96:97] op_sel:[0,0] op_sel_hi:[0,1]
    v_cvt_pk_bf16_f32 v114, v110, v111
    ds_write_b32 v63, v114 offset:11152
    v_pk_fma_f32 v[100:101], v[102:103], v[96:97], v[100:101] op_sel:[1,1,0] op_sel_hi:[1,0,1] neg_lo:[1,0,0]
    v_pk_mul_f32 v[106:107], v[104:105], v[98:99] op_sel:[0,0] op_sel_hi:[0,1]
    v_pk_fma_f32 v[106:107], v[104:105], v[98:99], v[106:107] op_sel:[1,1,0] op_sel_hi:[1,0,1] neg_lo:[1,0,0]
    v_cvt_pk_bf16_f32 v115, v100, v101
    v_cvt_pk_bf16_f32 v116, v106, v107
    ds_write_b32 v63, v116 offset:11424
    ds_write_b32 v63, v115 offset:3264
    v_pk_mul_f32 v[108:109], v[106:107], v[88:89] op_sel:[0,0] op_sel_hi:[0,1]
    v_pk_fma_f32 v[108:109], v[106:107], v[88:89], v[108:109] op_sel:[1,1,0] op_sel_hi:[1,0,1] neg_lo:[1,0,0]
    v_pk_mul_f32 v[102:103], v[100:101], v[96:97] op_sel:[0,0] op_sel_hi:[0,1]
    v_cvt_pk_bf16_f32 v117, v108, v109
    ds_write_b32 v63, v117 offset:11696
    v_pk_fma_f32 v[102:103], v[100:101], v[96:97], v[102:103] op_sel:[1,1,0] op_sel_hi:[1,0,1] neg_lo:[1,0,0]
    v_pk_mul_f32 v[104:105], v[106:107], v[98:99] op_sel:[0,0] op_sel_hi:[0,1]
    v_pk_fma_f32 v[104:105], v[106:107], v[98:99], v[104:105] op_sel:[1,1,0] op_sel_hi:[1,0,1] neg_lo:[1,0,0]
    v_cvt_pk_bf16_f32 v118, v102, v103
    v_cvt_pk_bf16_f32 v119, v104, v105
    ds_write_b32 v63, v119 offset:11968
    ds_write_b32 v63, v118 offset:3536
    v_pk_mul_f32 v[110:111], v[104:105], v[88:89] op_sel:[0,0] op_sel_hi:[0,1]
    v_pk_fma_f32 v[110:111], v[104:105], v[88:89], v[110:111] op_sel:[1,1,0] op_sel_hi:[1,0,1] neg_lo:[1,0,0]
    v_pk_mul_f32 v[100:101], v[102:103], v[96:97] op_sel:[0,0] op_sel_hi:[0,1]
    v_cvt_pk_bf16_f32 v113, v110, v111
    ds_write_b32 v63, v113 offset:12240
    v_pk_fma_f32 v[100:101], v[102:103], v[96:97], v[100:101] op_sel:[1,1,0] op_sel_hi:[1,0,1] neg_lo:[1,0,0]
    v_pk_mul_f32 v[106:107], v[104:105], v[98:99] op_sel:[0,0] op_sel_hi:[0,1]
    v_pk_fma_f32 v[106:107], v[104:105], v[98:99], v[106:107] op_sel:[1,1,0] op_sel_hi:[1,0,1] neg_lo:[1,0,0]
    v_cvt_pk_bf16_f32 v114, v100, v101
    v_cvt_pk_bf16_f32 v115, v106, v107
    ds_write_b32 v63, v115 offset:12512
    ds_write_b32 v63, v114 offset:3808
    v_pk_mul_f32 v[108:109], v[106:107], v[88:89] op_sel:[0,0] op_sel_hi:[0,1]
    v_pk_fma_f32 v[108:109], v[106:107], v[88:89], v[108:109] op_sel:[1,1,0] op_sel_hi:[1,0,1] neg_lo:[1,0,0]
    v_pk_mul_f32 v[102:103], v[100:101], v[96:97] op_sel:[0,0] op_sel_hi:[0,1]
    v_cvt_pk_bf16_f32 v116, v108, v109
    ds_write_b32 v63, v116 offset:12784
    v_pk_fma_f32 v[102:103], v[100:101], v[96:97], v[102:103] op_sel:[1,1,0] op_sel_hi:[1,0,1] neg_lo:[1,0,0]
    v_pk_mul_f32 v[104:105], v[106:107], v[98:99] op_sel:[0,0] op_sel_hi:[0,1]
    v_pk_fma_f32 v[104:105], v[106:107], v[98:99], v[104:105] op_sel:[1,1,0] op_sel_hi:[1,0,1] neg_lo:[1,0,0]
    v_cvt_pk_bf16_f32 v117, v102, v103
    v_cvt_pk_bf16_f32 v118, v104, v105
    ds_write_b32 v63, v118 offset:13056
    ds_write_b32 v63, v117 offset:4080
    v_pk_mul_f32 v[106:107], v[104:105], v[98:99] op_sel:[0,0] op_sel_hi:[0,1]
    v_pk_fma_f32 v[106:107], v[104:105], v[98:99], v[106:107] op_sel:[1,1,0] op_sel_hi:[1,0,1] neg_lo:[1,0,0]
    v_cvt_pk_bf16_f32 v119, v106, v107
    ds_write_b32 v63, v119 offset:13328
    v_pk_mul_f32 v[104:105], v[106:107], v[98:99] op_sel:[0,0] op_sel_hi:[0,1]
    v_pk_fma_f32 v[104:105], v[106:107], v[98:99], v[104:105] op_sel:[1,1,0] op_sel_hi:[1,0,1] neg_lo:[1,0,0]
    v_cvt_pk_bf16_f32 v113, v104, v105
    ds_write_b32 v63, v113 offset:13600
    v_pk_mul_f32 v[106:107], v[104:105], v[98:99] op_sel:[0,0] op_sel_hi:[0,1]
    v_pk_fma_f32 v[106:107], v[104:105], v[98:99], v[106:107] op_sel:[1,1,0] op_sel_hi:[1,0,1] neg_lo:[1,0,0]
    v_cvt_pk_bf16_f32 v114, v106, v107
    ds_write_b32 v63, v114 offset:13872
    v_pk_mul_f32 v[104:105], v[106:107], v[98:99] op_sel:[0,0] op_sel_hi:[0,1]
    v_pk_fma_f32 v[104:105], v[106:107], v[98:99], v[104:105] op_sel:[1,1,0] op_sel_hi:[1,0,1] neg_lo:[1,0,0]
    v_cvt_pk_bf16_f32 v115, v104, v105
    ds_write_b32 v63, v115 offset:14144
    v_pk_mul_f32 v[106:107], v[104:105], v[98:99] op_sel:[0,0] op_sel_hi:[0,1]
    v_pk_fma_f32 v[106:107], v[104:105], v[98:99], v[106:107] op_sel:[1,1,0] op_sel_hi:[1,0,1] neg_lo:[1,0,0]
    v_cvt_pk_bf16_f32 v116, v106, v107
    ds_write_b32 v63, v116 offset:14416
    v_pk_mul_f32 v[104:105], v[106:107], v[98:99] op_sel:[0,0] op_sel_hi:[0,1]
    v_pk_fma_f32 v[104:105], v[106:107], v[98:99], v[104:105] op_sel:[1,1,0] op_sel_hi:[1,0,1] neg_lo:[1,0,0]
    v_cvt_pk_bf16_f32 v117, v104, v105
    ds_write_b32 v63, v117 offset:14688
    v_pk_mul_f32 v[106:107], v[104:105], v[98:99] op_sel:[0,0] op_sel_hi:[0,1]
    v_pk_fma_f32 v[106:107], v[104:105], v[98:99], v[106:107] op_sel:[1,1,0] op_sel_hi:[1,0,1] neg_lo:[1,0,0]
    v_cvt_pk_bf16_f32 v118, v106, v107
    ds_write_b32 v63, v118 offset:14960
    v_pk_mul_f32 v[104:105], v[106:107], v[98:99] op_sel:[0,0] op_sel_hi:[0,1]
    v_pk_fma_f32 v[104:105], v[106:107], v[98:99], v[104:105] op_sel:[1,1,0] op_sel_hi:[1,0,1] neg_lo:[1,0,0]
    v_cvt_pk_bf16_f32 v119, v104, v105
    ds_write_b32 v63, v119 offset:15232
    s_setprio 3
    s_waitcnt vmcnt(0)
    s_mov_b32 s62, 1048576
Ltag_b:
    v_readfirstlane_b32 s60, v156
    v_readfirstlane_b32 s61, v157
    s_sub_u32 s62, s62, 1
    s_cbranch_scc1 Ltag_b_ok
    s_cmp_lg_u32 s60, 0
    s_cbranch_scc1 Ltag_b_ok
    s_sleep 2
    global_load_dwordx2 v[156:157], v23, s[36:37] sc1
    s_waitcnt vmcnt(0)
    s_branch Ltag_b
Ltag_b_ok:
    v_mov_b32 v14, s60
    s_mov_b64 exec, 1
    buffer_store_dword v14, v23, s[48:51], s55 offen sc1
    s_mov_b64 exec, -1
    ds_read_b64_tr_b16 v[148:149], v8 offset:0
    ds_read_b64_tr_b16 v[150:151], v8 offset:1024
    ds_read_b64_tr_b16 v[152:153], v8 offset:64
    ds_read_b64_tr_b16 v[154:155], v8 offset:1088
    s_setprio 0
    s_waitcnt lgkmcnt(0)
    s_barrier
    ds_read_b128 v[160:163], v64 offset:0
    ds_read_b128 v[164:167], v65 offset:4352
    ds_read_b128 v[168:171], v66 offset:13056
    ds_read_b128 v[172:175], v64 offset:64
    ds_read_b128 v[176:179], v65 offset:4416
    ds_read_b128 v[180:183], v66 offset:13120
    ds_read_b128 v[184:187], v64 offset:128
    ds_read_b128 v[188:191], v65 offset:4480
    ds_read_b128 v[192:195], v66 offset:13184
    ds_read_b128 v[196:199], v64 offset:192
    ds_read_b128 v[200:203], v65 offset:4544
    ds_read_b128 v[204:207], v66 offset:13248
    ds_read_b128 v[208:211], v64 offset:15504
    ds_read_b128 v[212:215], v65 offset:19856
    ds_read_b128 v[216:219], v66 offset:28560
    ds_read_b128 v[220:223], v64 offset:15568
    ds_read_b128 v[224:227], v65 offset:19920
    ds_read_b128 v[228:231], v66 offset:28624
    ds_read_b128 v[232:235], v64 offset:15632
    ds_read_b128 v[236:239], v65 offset:19984
    ds_read_b128 v[240:243], v66 offset:28688
    ds_read_b128 v[244:247], v64 offset:15696
    ds_read_b128 v[248:251], v65 offset:20048
    ds_read_b128 v[252:255], v66 offset:28752
    s_cmp_ge_u32 s10, 88
    s_cbranch_scc1 Lb_nowd
    s_setprio 3
    buffer_store_dwordx4 v[148:151], v10, s[48:51], s45 offen sc1
    buffer_store_dwordx4 v[152:155], v10, s[48:51], s46 offen sc1
    s_setprio 0
Lb_nowd:
    s_waitcnt lgkmcnt(15)
    v_mfma_f32_16x16x32_bf16 v[68:71], v[160:163], v[164:167], 0
    v_mfma_f32_16x16x32_bf16 v[72:75], v[160:163], v[168:171], 0
    s_waitcnt lgkmcnt(15)
    v_mfma_f32_16x16x32_bf16 v[68:71], v[172:175], v[176:179], v[68:71]
    v_mfma_f32_16x16x32_bf16 v[72:75], v[172:175], v[180:183], v[72:75]
    s_waitcnt lgkmcnt(15)
    v_mfma_f32_16x16x32_bf16 v[68:71], v[184:187], v[188:191], v[68:71]
    v_mfma_f32_16x16x32_bf16 v[72:75], v[184:187], v[192:195], v[72:75]
    s_waitcnt lgkmcnt(12)
    v_mfma_f32_16x16x32_bf16 v[68:71], v[196:199], v[200:203], v[68:71]
    v_mfma_f32_16x16x32_bf16 v[72:75], v[196:199], v[204:207], v[72:75]
    s_waitcnt lgkmcnt(9)
    v_mfma_f32_16x16x32_bf16 v[68:71], v[208:211], v[212:215], v[68:71]
    v_mfma_f32_16x16x32_bf16 v[72:75], v[208:211], v[216:219], v[72:75]
    s_waitcnt lgkmcnt(6)
    v_mfma_f32_16x16x32_bf16 v[68:71], v[220:223], v[224:227], v[68:71]
    v_mfma_f32_16x16x32_bf16 v[72:75], v[220:223], v[228:231], v[72:75]
    s_waitcnt lgkmcnt(3)
    v_mfma_f32_16x16x32_bf16 v[68:71], v[232:235], v[236:239], v[68:71]
    v_mfma_f32_16x16x32_bf16 v[72:75], v[232:235], v[240:243], v[72:75]
    s_waitcnt lgkmcnt(0)
    v_mfma_f32_16x16x32_bf16 v[68:71], v[244:247], v[248:251], v[68:71]
    v_mfma_f32_16x16x32_bf16 v[72:75], v[244:247], v[252:255], v[72:75]
    s_nop 6
    ds_write_b32 v60, v68 offset:0
    ds_write_b32 v62, v72 offset:0
    ds_write_b32 v60, v69 offset:32
    ds_write_b32 v62, v73 offset:32
    ds_write_b32 v60, v70 offset:64
    ds_write_b32 v62, v74 offset:64
    ds_write_b32 v60, v71 offset:96
    ds_write_b32 v62, v75 offset:96
    v_lshlrev_b32 v3, 4, v0
    s_waitcnt lgkmcnt(0)
    s_barrier
    ds_read2st64_b32 v[160:161], v128 offset0:0 offset1:35
    ds_read2st64_b32 v[162:163], v129 offset0:0 offset1:35
    ds_read2st64_b32 v[164:165], v130 offset0:0 offset1:35
    ds_read2st64_b32 v[166:167], v131 offset0:0 offset1:35
    ds_read2st64_b32 v[168:169], v132 offset0:0 offset1:35
    ds_read2st64_b32 v[170:171], v133 offset0:0 offset1:35
    ds_read2st64_b32 v[172:173], v134 offset0:0 offset1:35
    ds_read2st64_b32 v[174:175], v135 offset0:0 offset1:35
    ds_read2st64_b32 v[176:177], v136 offset0:0 offset1:35
    ds_read2st64_b32 v[178:179], v137 offset0:0 offset1:35
    ds_read2st64_b32 v[180:181], v138 offset0:0 offset1:35
    ds_write_b128 v123, v[52:55] offset:17920
    v_cmp_eq_u32 vcc, 255, v0
    s_waitcnt lgkmcnt(1)
    v_cvt_pk_bf16_f32 v16, v160, v162
    v_cvt_pk_bf16_f32 v17, v164, v166
    v_cvt_pk_bf16_f32 v18, v168, v170
    v_cvt_pk_bf16_f32 v19, v172, v174
    v_cvt_pk_bf16_f32 v20, v176, v178
    v_cvt_pk_bf16_f32 v21, v180, v180
    v_cndmask_b32 v20, v20, v52, vcc
    v_cndmask_b32 v21, v21, v52, vcc
    ds_write_b128 v3, v[16:19] offset:17920
    v_alignbit_b32 v196, v17, v16, 16
    v_alignbit_b32 v197, v18, v17, 16
    v_alignbit_b32 v198, v19, v18, 16
    v_alignbit_b32 v199, v20, v19, 16
    v_mov_b32 v200, v17
    v_mov_b32 v201, v18
    v_mov_b32 v202, v19
    v_mov_b32 v203, v20
    v_alignbit_b32 v204, v18, v17, 16
    v_alignbit_b32 v205, v19, v18, 16
    v_alignbit_b32 v206, v20, v19, 16
    v_alignbit_b32 v207, v21, v20, 16
    ds_write_b128 v3, v[196:199] offset:22080
    ds_write_b128 v3, v[200:203] offset:26240
    ds_write_b128 v3, v[204:207] offset:30400
    v_cvt_pk_bf16_f32 v24, v161, v163
    v_cvt_pk_bf16_f32 v25, v165, v167
    v_cvt_pk_bf16_f32 v26, v169, v171
    v_cvt_pk_bf16_f32 v27, v173, v175
    v_cvt_pk_bf16_f32 v28, v177, v179
    v_cvt_pk_bf16_f32 v29, v181, v181
    v_cndmask_b32 v28, v28, v52, vcc
    v_cndmask_b32 v29, v29, v52, vcc
    ds_write_b128 v3, v[24:27] offset:39168
    v_alignbit_b32 v212, v25, v24, 16
    v_alignbit_b32 v213, v26, v25, 16
    v_alignbit_b32 v214, v27, v26, 16
    v_alignbit_b32 v215, v28, v27, 16
    v_mov_b32 v216, v25
    v_mov_b32 v217, v26
    v_mov_b32 v218, v27
    v_mov_b32 v219, v28
    v_alignbit_b32 v220, v26, v25, 16
    v_alignbit_b32 v221, v27, v26, 16
    v_alignbit_b32 v222, v28, v27, 16
    v_alignbit_b32 v223, v29, v28, 16
    ds_write_b128 v3, v[212:215] offset:43328
    ds_write_b128 v3, v[216:219] offset:47488
    ds_write_b128 v3, v[220:223] offset:51648
    s_setprio 3
    s_waitcnt vmcnt(0)
    v_mov_b32 v14, s60
    s_mov_b64 exec, 1
    buffer_store_dword v14, v23, s[48:51], s11 offen sc1
    s_mov_b64 exec, -1
    s_waitcnt lgkmcnt(0)
    s_mov_b32 s58, s60
    s_mov_b32 s59, s60
    s_add_u32 s15, s14, 64
    s_mov_b32 s62, 12
Lse:
    s_load_dwordx16 s[16:31], s[48:49], s14 glc
    s_load_dwordx16 s[32:47], s[48:49], s15 glc
    s_waitcnt lgkmcnt(0)
    s_xor_b64 s[16:17], s[16:17], s[58:59]
    s_xor_b64 s[18:19], s[18:19], s[58:59]
    s_xor_b64 s[20:21], s[20:21], s[58:59]
    s_xor_b64 s[22:23], s[22:23], s[58:59]
    s_xor_b64 s[24:25], s[24:25], s[58:59]
    s_xor_b64 s[26:27], s[26:27], s[58:59]
    s_xor_b64 s[28:29], s[28:29], s[58:59]
    s_xor_b64 s[30:31], s[30:31], s[58:59]
    s_xor_b64 s[32:33], s[32:33], s[58:59]
    s_xor_b64 s[34:35], s[34:35], s[58:59]
    s_xor_b64 s[36:37], s[36:37], s[58:59]
    s_xor_b64 s[38:39], s[38:39], s[58:59]
    s_xor_b64 s[40:41], s[40:41], s[58:59]
    s_xor_b64 s[42:43], s[42:43], s[58:59]
    s_xor_b64 s[44:45], s[44:45], s[58:59]
    s_xor_b64 s[46:47], s[46:47], s[58:59]
    s_or_b64 s[16:17], s[16:17], s[18:19]
    s_or_b64 s[20:21], s[20:21], s[22:23]
    s_or_b64 s[24:25], s[24:25], s[26:27]
    s_or_b64 s[28:29], s[28:29], s[30:31]
    s_or_b64 s[32:33], s[32:33], s[34:35]
    s_or_b64 s[36:37], s[36:37], s[38:39]
    s_or_b64 s[40:41], s[40:41], s[42:43]
    s_or_b64 s[44:45], s[44:45], s[46:47]
    s_or_b64 s[16:17], s[16:17], s[20:21]
    s_or_b64 s[24:25], s[24:25], s[28:29]
    s_or_b64 s[32:33], s[32:33], s[36:37]
    s_or_b64 s[40:41], s[40:41], s[44:45]
    s_or_b64 s[16:17], s[16:17], s[24:25]
    s_or_b64 s[32:33], s[32:33], s[40:41]
    s_or_b64 s[16:17], s[16:17], s[32:33]
    s_cbranch_scc0 Lpoll_e_ok
    s_sleep 2
    s_sub_u32 s62, s62, 1
    s_cbranch_scc0 Lse
    s_mov_b32 s62, 1048576
    s_mov_b64 exec, -1
    s_branch Lpoll_e_in
Lpoll_e:
    s_sleep 8
Lpoll_e_in:
    buffer_load_dword v156, v126, s[48:51], 0 offen sc1
    s_waitcnt vmcnt(0)
    v_cmp_ne_u32 vcc, s60, v156
    s_sub_u32 s62, s62, 1
    s_cbranch_scc1 Lpoll_e_ok
    s_nop 0
    s_cbranch_vccnz Lpoll_e
Lpoll_e_ok:
    s_mov_b64 exec, -1
    s_setprio 3
    s_and_b32 s30, s8, 7
    s_lshl_b32 s22, s30, 9
    s_mul_i32 s23, s3, 88
    s_add_u32 s22, s22, s23
    s_add_u32 s22, s22, 13553664
    s_load_dwordx2 s[20:21], s[0:1], 112
    s_lshl_b32 s46, s4, 13
    s_add_u32 s44, s46, 7208960
    s_add_u32 s45, s46, 7213056
    buffer_load_dwordx4 v[56:59], v3, s[48:51], s44 offen
    buffer_load_dwordx4 v[100:103], v3, s[48:51], s45 offen
    v_mov_b32 v10, v120
    v_mov_b32 v11, v121
    v_mov_b32 v12, v122
    s_waitcnt vmcnt(0)
    ds_write_b128 v3, v[56:59] offset:35072
    ds_write_b128 v3, v[100:103] offset:56320
    s_waitcnt lgkmcnt(0)
    s_barrier
    s_setprio 0
    ds_read_b128 v[96:99], v11 offset:192
    ds_read_b64 v[64:65], v10 offset:3776
    ds_read_b64 v[66:67], v10 offset:3784
    ds_read_b128 v[100:103], v11 offset:704
    ds_read_b64 v[68:69], v10 offset:3264
    ds_read_b64 v[70:71], v10 offset:3272
    ds_read_b128 v[104:107], v11 offset:1216
    ds_read_b64 v[72:73], v10 offset:2752
    ds_read_b64 v[74:75], v10 offset:2760
    ds_read_b128 v[108:111], v11 offset:1728
    ds_read_b64 v[76:77], v10 offset:2240
    ds_read_b64 v[78:79], v10 offset:2248
    ds_read_b128 v[112:115], v11 offset:2240
    ds_read_b64 v[80:81], v10 offset:1728
    ds_read_b64 v[82:83], v10 offset:1736
    ds_read_b128 v[116:119], v11 offset:2752
    ds_read_b64 v[84:85], v10 offset:1216
    ds_read_b64 v[86:87], v10 offset:1224
    ds_read_b128 v[120:123], v11 offset:3264
    ds_read_b64 v[88:89], v10 offset:704
    ds_read_b64 v[90:91], v10 offset:712
    ds_read_b128 v[124:127], v11 offset:3776
    ds_read_b64 v[92:93], v10 offset:192
    ds_read_b64 v[94:95], v10 offset:200
    s_lshl_b32 s28, s9, 2
    s_lshr_b32 s29, s8, 3
    s_add_u32 s28, s28, s29
    s_lshl_b32 s10, s30, 1
    s_add_u32 s10, s10, s5
    s_lshl_b32 s11, s28, 1
    s_add_u32 s11, s11, s6
    s_mul_i32 s29, s3, 22528
    s_mul_i32 s24, s10, 90112
    s_xor_b32 s25, s10, 1
    s_mul_i32 s25, s25, 90112
    s_mul_i32 s26, s11, 90112
    s_xor_b32 s27, s11, 1
    s_mul_i32 s27, s27, 90112
    s_add_u32 s26, s26, s29
    s_add_u32 s27, s27, s29
    s_add_u32 s29, s29, 5767168
    s_add_u32 s24, s24, s29
    s_add_u32 s25, s25, s29
    v_lshlrev_b32 v13, 4, v2
    s_lshl_b32 s31, s3, 12
    s_add_u32 s32, s24, 13312
    s_add_u32 s33, s25, 13312
    v_min_u32 v9, 21, v2
    v_lshl_add_u32 v9, v9, 2, s22
    s_add_u32 s22, s22, s48
    s_addc_u32 s23, s49, 0
    s_waitcnt lgkmcnt(0)
    s_load_dwordx8 s[36:43], s[22:23], 0
    s_load_dwordx4 s[16:19], s[22:23], 32
    s_load_dwordx4 s[96:99], s[22:23], 48
    s_load_dwordx2 s[44:45], s[22:23], 64
    s_load_dwordx2 s[34:35], s[22:23], 72
    s_load_dwordx2 s[56:57], s[22:23], 80
    v_mfma_f32_16x16x32_bf16 v[192:195], v[64:67], v[96:99], 0
    ds_read_b128 v[160:163], v11 offset:128
    v_mfma_f32_16x16x32_bf16 v[196:199], v[64:67], v[100:103], 0
    ds_read_b64 v[128:129], v10 offset:3712
    v_mfma_f32_16x16x32_bf16 v[200:203], v[64:67], v[104:107], 0
    ds_read_b64 v[130:131], v10 offset:3720
    v_mfma_f32_16x16x32_bf16 v[204:207], v[64:67], v[108:111], 0
    ds_read_b128 v[164:167], v11 offset:640
    v_mfma_f32_16x16x32_bf16 v[208:211], v[64:67], v[112:115], 0
    ds_read_b64 v[132:133], v10 offset:3200
    v_mfma_f32_16x16x32_bf16 v[212:215], v[64:67], v[116:119], 0
    ds_read_b64 v[134:135], v10 offset:3208
    v_mfma_f32_16x16x32_bf16 v[216:219], v[64:67], v[120:123], 0
    ds_read_b128 v[168:171], v11 offset:1152
    v_mfma_f32_16x16x32_bf16 v[220:223], v[64:67], v[124:127], 0
    ds_read_b64 v[136:137], v10 offset:2688
    v_mfma_f32_16x16x32_bf16 v[196:199], v[68:71], v[96:99], v[196:199]
    ds_read_b64 v[138:139], v10 offset:2696
    v_mfma_f32_16x16x32_bf16 v[200:203], v[68:71], v[100:103], v[200:203]
    ds_read_b128 v[172:175], v11 offset:1664
    v_mfma_f32_16x16x32_bf16 v[204:207], v[68:71], v[104:107], v[204:207]
    ds_read_b64 v[140:141], v10 offset:2176
    v_mfma_f32_16x16x32_bf16 v[208:211], v[68:71], v[108:111], v[208:211]
    ds_read_b64 v[142:143], v10 offset:2184
    v_mfma_f32_16x16x32_bf16 v[212:215], v[68:71], v[112:115], v[212:215]
    ds_read_b128 v[176:179], v11 offset:2176
    v_mfma_f32_16x16x32_bf16 v[216:219], v[68:71], v[116:119], v[216:219]
    ds_read_b64 v[144:145], v10 offset:1664
    v_mfma_f32_16x16x32_bf16 v[220:223], v[68:71], v[120:123], v[220:223]
    ds_read_b64 v[146:147], v10 offset:1672
    v_mfma_f32_16x16x32_bf16 v[200:203], v[72:75], v[96:99], v[200:203]
    ds_read_b128 v[180:183], v11 offset:2688
    v_mfma_f32_16x16x32_bf16 v[204:207], v[72:75], v[100:103], v[204:207]
    ds_read_b64 v[148:149], v10 offset:1152
    v_mfma_f32_16x16x32_bf16 v[208:211], v[72:75], v[104:107], v[208:211]
    ds_read_b64 v[150:151], v10 offset:1160
    v_mfma_f32_16x16x32_bf16 v[212:215], v[72:75], v[108:111], v[212:215]
    ds_read_b128 v[184:187], v11 offset:3200
    v_mfma_f32_16x16x32_bf16 v[216:219], v[72:75], v[112:115], v[216:219]
    ds_read_b64 v[152:153], v10 offset:640
    v_mfma_f32_16x16x32_bf16 v[220:223], v[72:75], v[116:119], v[220:223]
    ds_read_b64 v[154:155], v10 offset:648
    v_mfma_f32_16x16x32_bf16 v[204:207], v[76:79], v[96:99], v[204:207]
    ds_read_b128 v[188:191], v11 offset:3712
    v_mfma_f32_16x16x32_bf16 v[208:211], v[76:79], v[100:103], v[208:211]
    ds_read_b64 v[156:157], v10 offset:128
    v_mfma_f32_16x16x32_bf16 v[212:215], v[76:79], v[104:107], v[212:215]
    ds_read_b64 v[158:159], v10 offset:136
    v_mfma_f32_16x16x32_bf16 v[216:219], v[76:79], v[108:111], v[216:219]
    v_mfma_f32_16x16x32_bf16 v[220:223], v[76:79], v[112:115], v[220:223]
    v_mfma_f32_16x16x32_bf16 v[208:211], v[80:83], v[96:99], v[208:211]
    v_mfma_f32_16x16x32_bf16 v[212:215], v[80:83], v[100:103], v[212:215]
    v_mfma_f32_16x16x32_bf16 v[216:219], v[80:83], v[104:107], v[216:219]
    v_mfma_f32_16x16x32_bf16 v[220:223], v[80:83], v[108:111], v[220:223]
    v_mfma_f32_16x16x32_bf16 v[212:215], v[84:87], v[96:99], v[212:215]
    v_mfma_f32_16x16x32_bf16 v[216:219], v[84:87], v[100:103], v[216:219]
    v_mfma_f32_16x16x32_bf16 v[220:223], v[84:87], v[104:107], v[220:223]
    v_mfma_f32_16x16x32_bf16 v[216:219], v[88:91], v[96:99], v[216:219]
    v_mfma_f32_16x16x32_bf16 v[220:223], v[88:91], v[100:103], v[220:223]
    v_mfma_f32_16x16x32_bf16 v[220:223], v[92:95], v[96:99], v[220:223]
    s_waitcnt lgkmcnt(0)
    s_xor_b64 s[36:37], s[36:37], s[58:59]
    s_xor_b64 s[38:39], s[38:39], s[58:59]
    s_xor_b64 s[40:41], s[40:41], s[58:59]
    s_xor_b64 s[42:43], s[42:43], s[58:59]
    s_xor_b64 s[16:17], s[16:17], s[58:59]
    s_xor_b64 s[18:19], s[18:19], s[58:59]
    s_xor_b64 s[96:97], s[96:97], s[58:59]
    s_xor_b64 s[98:99], s[98:99], s[58:59]
    s_xor_b64 s[44:45], s[44:45], s[58:59]
    s_xor_b64 s[34:35], s[34:35], s[58:59]
    s_xor_b64 s[56:57], s[56:57], s[58:59]
    s_or_b64 s[36:37], s[36:37], s[38:39]
    s_or_b64 s[36:37], s[36:37], s[40:41]
    s_or_b64 s[36:37], s[36:37], s[42:43]
    s_or_b64 s[36:37], s[36:37], s[16:17]
    s_or_b64 s[36:37], s[36:37], s[18:19]
    s_or_b64 s[36:37], s[36:37], s[96:97]
    s_or_b64 s[36:37], s[36:37], s[98:99]
    s_or_b64 s[36:37], s[36:37], s[44:45]
    s_or_b64 s[36:37], s[36:37], s[34:35]
    s_or_b64 s[36:37], s[36:37], s[56:57]
    s_cbranch_scc0 Lpoll_w_ok
    s_mov_b32 s62, 1048576
    s_mov_b64 exec, -1
    s_branch Lpoll_w_in
Lpoll_w:
    s_sleep 8
Lpoll_w_in:
    buffer_load_dword v18, v9, s[48:51], 0 offen sc1
    s_waitcnt vmcnt(0)
    v_cmp_ne_u32 vcc, s60, v18
    s_sub_u32 s62, s62, 1
    s_cbranch_scc1 Lpoll_w_ok
    s_nop 0
    s_cbranch_vccnz Lpoll_w
Lpoll_w_ok:
    s_mov_b64 exec, -1
    v_mfma_f32_16x16x32_bf16 v[192:195], v[128:131], v[160:163], v[192:195]
    ds_read_b128 v[96:99], v11 offset:64
    v_mfma_f32_16x16x32_bf16 v[196:199], v[128:131], v[164:167], v[196:199]
    ds_read_b64 v[64:65], v10 offset:3648
    v_mfma_f32_16x16x32_bf16 v[200:203], v[128:131], v[168:171], v[200:203]
    ds_read_b64 v[66:67], v10 offset:3656
    v_mfma_f32_16x16x32_bf16 v[204:207], v[128:131], v[172:175], v[204:207]
    ds_read_b128 v[100:103], v11 offset:576
    v_mfma_f32_16x16x32_bf16 v[208:211], v[128:131], v[176:179], v[208:211]
    ds_read_b64 v[68:69], v10 offset:3136
    v_mfma_f32_16x16x32_bf16 v[212:215], v[128:131], v[180:183], v[212:215]
    ds_read_b64 v[70:71], v10 offset:3144
    v_mfma_f32_16x16x32_bf16 v[216:219], v[128:131], v[184:187], v[216:219]
    ds_read_b128 v[104:107], v11 offset:1088
    v_mfma_f32_16x16x32_bf16 v[220:223], v[128:131], v[188:191], v[220:223]
    ds_read_b64 v[72:73], v10 offset:2624
    v_mfma_f32_16x16x32_bf16 v[196:199], v[132:135], v[160:163], v[196:199]
    ds_read_b64 v[74:75], v10 offset:2632
    v_mfma_f32_16x16x32_bf16 v[200:203], v[132:135], v[164:167], v[200:203]
    ds_read_b128 v[108:111], v11 offset:1600
    v_mfma_f32_16x16x32_bf16 v[204:207], v[132:135], v[168:171], v[204:207]
    ds_read_b64 v[76:77], v10 offset:2112
    v_mfma_f32_16x16x32_bf16 v[208:211], v[132:135], v[172:175], v[208:211]
    ds_read_b64 v[78:79], v10 offset:2120
    v_mfma_f32_16x16x32_bf16 v[212:215], v[132:135], v[176:179], v[212:215]
    ds_read_b128 v[112:115], v11 offset:2112
    v_mfma_f32_16x16x32_bf16 v[216:219], v[132:135], v[180:183], v[216:219]
    ds_read_b64 v[80:81], v10 offset:1600
    v_mfma_f32_16x16x32_bf16 v[220:223], v[132:135], v[184:187], v[220:223]
    ds_read_b64 v[82:83], v10 offset:1608
    v_mfma_f32_16x16x32_bf16 v[200:203], v[136:139], v[160:163], v[200:203]
    ds_read_b128 v[116:119], v11 offset:2624
    v_mfma_f32_16x16x32_bf16 v[204:207], v[136:139], v[164:167], v[204:207]
    ds_read_b64 v[84:85], v10 offset:1088
    v_mfma_f32_16x16x32_bf16 v[208:211], v[136:139], v[168:171], v[208:211]
    ds_read_b64 v[86:87], v10 offset:1096
    v_mfma_f32_16x16x32_bf16 v[212:215], v[136:139], v[172:175], v[212:215]
    ds_read_b128 v[120:123], v11 offset:3136
    v_mfma_f32_16x16x32_bf16 v[216:219], v[136:139], v[176:179], v[216:219]
    ds_read_b64 v[88:89], v10 offset:576
    v_mfma_f32_16x16x32_bf16 v[220:223], v[136:139], v[180:183], v[220:223]
    ds_read_b64 v[90:91], v10 offset:584
    v_mfma_f32_16x16x32_bf16 v[204:207], v[140:143], v[160:163], v[204:207]
    ds_read_b128 v[124:127], v11 offset:3648
    v_mfma_f32_16x16x32_bf16 v[208:211], v[140:143], v[164:167], v[208:211]
    ds_read_b64 v[92:93], v10 offset:64
    v_mfma_f32_16x16x32_bf16 v[212:215], v[140:143], v[168:171], v[212:215]
    ds_read_b64 v[94:95], v10 offset:72
    v_mfma_f32_16x16x32_bf16 v[216:219], v[140:143], v[172:175], v[216:219]
    buffer_load_dwordx4 v[24:27], v13, s[48:51], s24 offen offset:0
    v_mfma_f32_16x16x32_bf16 v[220:223], v[140:143], v[176:179], v[220:223]
    buffer_load_dwordx4 v[28:31], v13, s[48:51], s25 offen offset:0
    v_mfma_f32_16x16x32_bf16 v[208:211], v[144:147], v[160:163], v[208:211]
    buffer_load_dwordx4 v[32:35], v13, s[48:51], s24 offen offset:1024
    v_mfma_f32_16x16x32_bf16 v[212:215], v[144:147], v[164:167], v[212:215]
    buffer_load_dwordx4 v[36:39], v13, s[48:51], s25 offen offset:1024
    v_mfma_f32_16x16x32_bf16 v[216:219], v[144:147], v[168:171], v[216:219]
    buffer_load_dwordx4 v[40:43], v13, s[48:51], s24 offen offset:2048
    v_mfma_f32_16x16x32_bf16 v[220:223], v[144:147], v[172:175], v[220:223]
    buffer_load_dwordx4 v[44:47], v13, s[48:51], s25 offen offset:2048
    v_mfma_f32_16x16x32_bf16 v[212:215], v[148:151], v[160:163], v[212:215]
    buffer_load_dwordx4 v[48:51], v13, s[48:51], s24 offen offset:3072
    v_mfma_f32_16x16x32_bf16 v[216:219], v[148:151], v[164:167], v[216:219]
    buffer_load_dwordx4 v[52:55], v13, s[48:51], s25 offen offset:3072
    s_add_u32 s24, s24, 4096
    s_add_u32 s25, s25, 4096
    v_mfma_f32_16x16x32_bf16 v[220:223], v[148:151], v[168:171], v[220:223]
    buffer_load_dwordx4 v[56:59], v13, s[48:51], s24 offen offset:0
    v_mfma_f32_16x16x32_bf16 v[216:219], v[152:155], v[160:163], v[216:219]
    buffer_load_dwordx4 v[60:63], v13, s[48:51], s25 offen offset:0
    v_mfma_f32_16x16x32_bf16 v[220:223], v[152:155], v[164:167], v[220:223]
    buffer_load_dwordx4 v[224:227], v13, s[48:51], s24 offen offset:1024
    v_mfma_f32_16x16x32_bf16 v[220:223], v[156:159], v[160:163], v[220:223]
    buffer_load_dwordx4 v[228:231], v13, s[48:51], s25 offen offset:1024
    s_waitcnt lgkmcnt(0)
    v_mfma_f32_16x16x32_bf16 v[192:195], v[64:67], v[96:99], v[192:195]
    ds_read_b128 v[160:163], v11 offset:0
    v_mfma_f32_16x16x32_bf16 v[196:199], v[64:67], v[100:103], v[196:199]
    ds_read_b64 v[128:129], v10 offset:3584
    v_mfma_f32_16x16x32_bf16 v[200:203], v[64:67], v[104:107], v[200:203]
    ds_read_b64 v[130:131], v10 offset:3592
    v_mfma_f32_16x16x32_bf16 v[204:207], v[64:67], v[108:111], v[204:207]
    ds_read_b128 v[164:167], v11 offset:512
    v_mfma_f32_16x16x32_bf16 v[208:211], v[64:67], v[112:115], v[208:211]
    ds_read_b64 v[132:133], v10 offset:3072
    v_mfma_f32_16x16x32_bf16 v[212:215], v[64:67], v[116:119], v[212:215]
    ds_read_b64 v[134:135], v10 offset:3080
    v_mfma_f32_16x16x32_bf16 v[216:219], v[64:67], v[120:123], v[216:219]
    ds_read_b128 v[168:171], v11 offset:1024
    v_mfma_f32_16x16x32_bf16 v[220:223], v[64:67], v[124:127], v[220:223]
    ds_read_b64 v[136:137], v10 offset:2560
    v_mfma_f32_16x16x32_bf16 v[196:199], v[68:71], v[96:99], v[196:199]
    ds_read_b64 v[138:139], v10 offset:2568
    v_mfma_f32_16x16x32_bf16 v[200:203], v[68:71], v[100:103], v[200:203]
    ds_read_b128 v[172:175], v11 offset:1536
    v_mfma_f32_16x16x32_bf16 v[204:207], v[68:71], v[104:107], v[204:207]
    ds_read_b64 v[140:141], v10 offset:2048
    v_mfma_f32_16x16x32_bf16 v[208:211], v[68:71], v[108:111], v[208:211]
    ds_read_b64 v[142:143], v10 offset:2056
    v_mfma_f32_16x16x32_bf16 v[212:215], v[68:71], v[112:115], v[212:215]
    ds_read_b128 v[176:179], v11 offset:2048
    v_mfma_f32_16x16x32_bf16 v[216:219], v[68:71], v[116:119], v[216:219]
    ds_read_b64 v[144:145], v10 offset:1536
    v_mfma_f32_16x16x32_bf16 v[220:223], v[68:71], v[120:123], v[220:223]
    ds_read_b64 v[146:147], v10 offset:1544
    v_mfma_f32_16x16x32_bf16 v[200:203], v[72:75], v[96:99], v[200:203]
    ds_read_b128 v[180:183], v11 offset:2560
    v_mfma_f32_16x16x32_bf16 v[204:207], v[72:75], v[100:103], v[204:207]
    ds_read_b64 v[148:149], v10 offset:1024
    v_mfma_f32_16x16x32_bf16 v[208:211], v[72:75], v[104:107], v[208:211]
    ds_read_b64 v[150:151], v10 offset:1032
    v_mfma_f32_16x16x32_bf16 v[212:215], v[72:75], v[108:111], v[212:215]
    ds_read_b128 v[184:187], v11 offset:3072
    v_mfma_f32_16x16x32_bf16 v[216:219], v[72:75], v[112:115], v[216:219]
    ds_read_b64 v[152:153], v10 offset:512
    v_mfma_f32_16x16x32_bf16 v[220:223], v[72:75], v[116:119], v[220:223]
    ds_read_b64 v[154:155], v10 offset:520
    v_mfma_f32_16x16x32_bf16 v[204:207], v[76:79], v[96:99], v[204:207]
    ds_read_b128 v[188:191], v11 offset:3584
    v_mfma_f32_16x16x32_bf16 v[208:211], v[76:79], v[100:103], v[208:211]
    ds_read_b64 v[156:157], v10 offset:0
    v_mfma_f32_16x16x32_bf16 v[212:215], v[76:79], v[104:107], v[212:215]
    ds_read_b64 v[158:159], v10 offset:8
    v_mfma_f32_16x16x32_bf16 v[216:219], v[76:79], v[108:111], v[216:219]
    buffer_load_dwordx4 v[232:235], v13, s[48:51], s24 offen offset:2048
    v_mfma_f32_16x16x32_bf16 v[220:223], v[76:79], v[112:115], v[220:223]
    buffer_load_dwordx4 v[236:239], v13, s[48:51], s25 offen offset:2048
    v_mfma_f32_16x16x32_bf16 v[208:211], v[80:83], v[96:99], v[208:211]
    buffer_load_dwordx4 v[240:243], v13, s[48:51], s24 offen offset:3072
    v_mfma_f32_16x16x32_bf16 v[212:215], v[80:83], v[100:103], v[212:215]
    buffer_load_dwordx4 v[244:247], v13, s[48:51], s25 offen offset:3072
    s_add_u32 s24, s24, 4096
    s_add_u32 s25, s25, 4096
    v_mfma_f32_16x16x32_bf16 v[216:219], v[80:83], v[104:107], v[216:219]
    buffer_load_dwordx4 v[248:251], v13, s[48:51], s24 offen offset:0
    v_mfma_f32_16x16x32_bf16 v[220:223], v[80:83], v[108:111], v[220:223]
    buffer_load_dwordx4 v[252:255], v13, s[48:51], s25 offen offset:0
    v_mfma_f32_16x16x32_bf16 v[212:215], v[84:87], v[96:99], v[212:215]
    s_add_u32 m0, s31, 0
    s_nop 0
    buffer_load_dwordx4 v13, s[48:51], s32 offen lds
    s_add_u32 s32, s32, 1024
    v_mfma_f32_16x16x32_bf16 v[216:219], v[84:87], v[100:103], v[216:219]
    s_add_u32 m0, s31, 1024
    s_nop 0
    buffer_load_dwordx4 v13, s[48:51], s33 offen lds
    s_add_u32 s33, s33, 1024
    v_mfma_f32_16x16x32_bf16 v[220:223], v[84:87], v[104:107], v[220:223]
    s_add_u32 m0, s31, 2048
    s_nop 0
    buffer_load_dwordx4 v13, s[48:51], s32 offen lds
    s_add_u32 s32, s32, 1024
    v_mfma_f32_16x16x32_bf16 v[216:219], v[88:91], v[96:99], v[216:219]
    s_add_u32 m0, s31, 3072
    s_nop 0
    buffer_load_dwordx4 v13, s[48:51], s33 offen lds
    s_add_u32 s33, s33, 1024
    v_mfma_f32_16x16x32_bf16 v[220:223], v[88:91], v[100:103], v[220:223]
    v_mfma_f32_16x16x32_bf16 v[220:223], v[92:95], v[96:99], v[220:223]
    s_waitcnt lgkmcnt(0)
    v_mfma_f32_16x16x32_bf16 v[192:195], v[128:131], v[160:163], v[192:195]
    buffer_load_dwordx4 v[64:67], v13, s[48:51], s24 offen offset:1024
    v_mfma_f32_16x16x32_bf16 v[196:199], v[128:131], v[164:167], v[196:199]
    buffer_load_dwordx4 v[68:71], v13, s[48:51], s25 offen offset:1024
    v_mfma_f32_16x16x32_bf16 v[200:203], v[128:131], v[168:171], v[200:203]
    buffer_load_dwordx4 v[72:75], v13, s[48:51], s24 offen offset:2048
    v_mfma_f32_16x16x32_bf16 v[204:207], v[128:131], v[172:175], v[204:207]
    buffer_load_dwordx4 v[76:79], v13, s[48:51], s25 offen offset:2048
    v_mfma_f32_16x16x32_bf16 v[208:211], v[128:131], v[176:179], v[208:211]
    buffer_load_dwordx4 v[80:83], v13, s[48:51], s24 offen offset:3072
    v_mfma_f32_16x16x32_bf16 v[212:215], v[128:131], v[180:183], v[212:215]
    buffer_load_dwordx4 v[84:87], v13, s[48:51], s25 offen offset:3072
    s_add_u32 s24, s24, 4096
    s_add_u32 s25, s25, 4096
    v_mfma_f32_16x16x32_bf16 v[216:219], v[128:131], v[184:187], v[216:219]
    buffer_load_dwordx4 v[88:91], v13, s[48:51], s24 offen offset:0
    v_mfma_f32_16x16x32_bf16 v[220:223], v[128:131], v[188:191], v[220:223]
    buffer_load_dwordx4 v[92:95], v13, s[48:51], s25 offen offset:0
    v_mfma_f32_16x16x32_bf16 v[196:199], v[132:135], v[160:163], v[196:199]
    v_mfma_f32_16x16x32_bf16 v[200:203], v[132:135], v[164:167], v[200:203]
    v_mfma_f32_16x16x32_bf16 v[204:207], v[132:135], v[168:171], v[204:207]
    v_mfma_f32_16x16x32_bf16 v[208:211], v[132:135], v[172:175], v[208:211]
    v_mfma_f32_16x16x32_bf16 v[212:215], v[132:135], v[176:179], v[212:215]
    v_mfma_f32_16x16x32_bf16 v[216:219], v[132:135], v[180:183], v[216:219]
    v_mfma_f32_16x16x32_bf16 v[220:223], v[132:135], v[184:187], v[220:223]
    v_mfma_f32_16x16x32_bf16 v[200:203], v[136:139], v[160:163], v[200:203]
    v_mfma_f32_16x16x32_bf16 v[204:207], v[136:139], v[164:167], v[204:207]
    v_mfma_f32_16x16x32_bf16 v[208:211], v[136:139], v[168:171], v[208:211]
    v_mfma_f32_16x16x32_bf16 v[212:215], v[136:139], v[172:175], v[212:215]
    v_mfma_f32_16x16x32_bf16 v[216:219], v[136:139], v[176:179], v[216:219]
    v_mfma_f32_16x16x32_bf16 v[220:223], v[136:139], v[180:183], v[220:223]
    v_mfma_f32_16x16x32_bf16 v[204:207], v[140:143], v[160:163], v[204:207]
    v_mfma_f32_16x16x32_bf16 v[208:211], v[140:143], v[164:167], v[208:211]
    v_mfma_f32_16x16x32_bf16 v[212:215], v[140:143], v[168:171], v[212:215]
    v_mfma_f32_16x16x32_bf16 v[216:219], v[140:143], v[172:175], v[216:219]
    v_mfma_f32_16x16x32_bf16 v[220:223], v[140:143], v[176:179], v[220:223]
    v_mfma_f32_16x16x32_bf16 v[208:211], v[144:147], v[160:163], v[208:211]
    v_mfma_f32_16x16x32_bf16 v[212:215], v[144:147], v[164:167], v[212:215]
    v_mfma_f32_16x16x32_bf16 v[216:219], v[144:147], v[168:171], v[216:219]
    v_mfma_f32_16x16x32_bf16 v[220:223], v[144:147], v[172:175], v[220:223]
    v_mfma_f32_16x16x32_bf16 v[212:215], v[148:151], v[160:163], v[212:215]
    v_mfma_f32_16x16x32_bf16 v[216:219], v[148:151], v[164:167], v[216:219]
    v_mfma_f32_16x16x32_bf16 v[220:223], v[148:151], v[168:171], v[220:223]
    v_mfma_f32_16x16x32_bf16 v[216:219], v[152:155], v[160:163], v[216:219]
    v_mfma_f32_16x16x32_bf16 v[220:223], v[152:155], v[164:167], v[220:223]
    v_mfma_f32_16x16x32_bf16 v[220:223], v[156:159], v[160:163], v[220:223]
    s_lshl_b32 s14, s3, 12
    s_add_u32 s14, s14, 60416
    v_add_u32 v14, s14, v13
    s_xor_b32 s15, s3, 1
    s_lshl_b32 s15, s15, 12
    s_add_u32 s15, s15, 60416
    v_add_u32 v15, s15, v13
    s_lshl_b32 s13, s6, 11
    s_add_u32 s14, s12, s13
    s_add_u32 s14, s14, 17152
    v_add_u32 v16, s14, v12
    s_nop 7
    s_cmp_eq_u32 s6, 0
    s_cbranch_scc1 Lc_lo
    ds_write_b128 v14, v[192:195] offset:0
    ds_write_b128 v14, v[196:199] offset:1024
    ds_write_b128 v14, v[200:203] offset:2048
    ds_write_b128 v14, v[204:207] offset:3072
    v_mov_b32 v160, v208
    v_mov_b32 v161, v209
    v_mov_b32 v162, v210
    v_mov_b32 v163, v211
    v_mov_b32 v164, v212
    v_mov_b32 v165, v213
    v_mov_b32 v166, v214
    v_mov_b32 v167, v215
    v_mov_b32 v168, v216
    v_mov_b32 v169, v217
    v_mov_b32 v170, v218
    v_mov_b32 v171, v219
    v_mov_b32 v172, v220
    v_mov_b32 v173, v221
    v_mov_b32 v174, v222
    v_mov_b32 v175, v223
    s_branch Lc_join
Lc_lo:
    ds_write_b128 v14, v[208:211] offset:0
    ds_write_b128 v14, v[212:215] offset:1024
    ds_write_b128 v14, v[216:219] offset:2048
    ds_write_b128 v14, v[220:223] offset:3072
    v_mov_b32 v160, v192
    v_mov_b32 v161, v193
    v_mov_b32 v162, v194
    v_mov_b32 v163, v195
    v_mov_b32 v164, v196
    v_mov_b32 v165, v197
    v_mov_b32 v166, v198
    v_mov_b32 v167, v199
    v_mov_b32 v168, v200
    v_mov_b32 v169, v201
    v_mov_b32 v170, v202
    v_mov_b32 v171, v203
    v_mov_b32 v172, v204
    v_mov_b32 v173, v205
    v_mov_b32 v174, v206
    v_mov_b32 v175, v207
Lc_join:
    ds_read_b64 v[128:129], v16 offset:0
    ds_read_b64 v[130:131], v16 offset:512
    ds_read_b64 v[132:133], v16 offset:1024
    ds_read_b64 v[134:135], v16 offset:1536
    s_waitcnt lgkmcnt(0)
    s_barrier
    s_lshl_b32 s14, s5, 12
    s_add_u32 s14, s14, s46
    s_add_u32 s14, s14, s13
    s_add_u32 s14, s14, 11403264
    ds_read_b128 v[176:179], v15 offset:0
    ds_read_b128 v[180:183], v15 offset:1024
    ds_read_b128 v[184:187], v15 offset:2048
    ds_read_b128 v[188:191], v15 offset:3072
    v_lshlrev_b32 v136, 16, v128
    v_and_b32 v137, s54, v128
    v_fmac_f32 v160, v136, v5
    v_fmac_f32 v161, v137, v5
    v_lshlrev_b32 v136, 16, v129
    v_and_b32 v137, s54, v129
    v_fmac_f32 v162, v136, v5
    v_fmac_f32 v163, v137, v5
    v_lshlrev_b32 v136, 16, v130
    v_and_b32 v137, s54, v130
    v_fmac_f32 v164, v136, v5
    v_fmac_f32 v165, v137, v5
    v_lshlrev_b32 v136, 16, v131
    v_and_b32 v137, s54, v131
    v_fmac_f32 v166, v136, v5
    v_fmac_f32 v167, v137, v5
    v_lshlrev_b32 v136, 16, v132
    v_and_b32 v137, s54, v132
    v_fmac_f32 v168, v136, v5
    v_fmac_f32 v169, v137, v5
    v_lshlrev_b32 v136, 16, v133
    v_and_b32 v137, s54, v133
    v_fmac_f32 v170, v136, v5
    v_fmac_f32 v171, v137, v5
    v_lshlrev_b32 v136, 16, v134
    v_and_b32 v137, s54, v134
    v_fmac_f32 v172, v136, v5
    v_fmac_f32 v173, v137, v5
    v_lshlrev_b32 v136, 16, v135
    v_and_b32 v137, s54, v135
    v_fmac_f32 v174, v136, v5
    v_fmac_f32 v175, v137, v5
    s_waitcnt lgkmcnt(0)
    s_setprio 3
    v_pk_add_f32 v[160:161], v[160:161], v[176:177]
    v_pk_add_f32 v[162:163], v[162:163], v[178:179]
    v_pk_add_f32 v[164:165], v[164:165], v[180:181]
    v_pk_add_f32 v[166:167], v[166:167], v[182:183]
    v_pk_add_f32 v[168:169], v[168:169], v[184:185]
    v_pk_add_f32 v[170:171], v[170:171], v[186:187]
    v_pk_add_f32 v[172:173], v[172:173], v[188:189]
    v_pk_add_f32 v[174:175], v[174:175], v[190:191]
    v_cvt_pk_bf16_f32 v192, v160, v161
    v_cvt_pk_bf16_f32 v193, v162, v163
    buffer_store_dwordx2 v[192:193], v12, s[48:51], s14 offen offset:0 sc1
    v_cvt_pk_bf16_f32 v194, v164, v165
    v_cvt_pk_bf16_f32 v195, v166, v167
    buffer_store_dwordx2 v[194:195], v12, s[48:51], s14 offen offset:512 sc1
    v_cvt_pk_bf16_f32 v196, v168, v169
    v_cvt_pk_bf16_f32 v197, v170, v171
    buffer_store_dwordx2 v[196:197], v12, s[48:51], s14 offen offset:1024 sc1
    v_cvt_pk_bf16_f32 v198, v172, v173
    v_cvt_pk_bf16_f32 v199, v174, v175
    buffer_store_dwordx2 v[198:199], v12, s[48:51], s14 offen offset:1536 sc1
    v_mov_b32 v3, v13
    v_add_u32 v11, s31, v13
    s_waitcnt vmcnt(0)
    s_barrier
    s_cmp_lg_u32 s3, 0
    s_cbranch_scc1 Lfl_l
    v_mov_b32 v14, s60
    v_mov_b32 v15, s61
    v_mov_b32 v13, s63
    s_mov_b64 exec, 1
    buffer_store_dwordx2 v[14:15], v13, s[48:51], 0 offen offset:0 sc1
    s_mov_b64 exec, -1
Lfl_l:
    s_setprio 0
    v_mov_b32 v13, v3
    s_mul_i32 s31, s3, 14336
    s_add_u32 m0, s31, 16384
    s_nop 0
    buffer_load_dwordx4 v13, s[48:51], s32 offen lds
    s_add_u32 s32, s32, 1024
    s_add_u32 m0, s31, 17408
    s_nop 0
    buffer_load_dwordx4 v13, s[48:51], s33 offen lds
    s_add_u32 s33, s33, 1024
    s_add_u32 m0, s31, 18432
    s_nop 0
    buffer_load_dwordx4 v13, s[48:51], s32 offen lds
    s_add_u32 s32, s32, 1024
    s_add_u32 m0, s31, 19456
    s_nop 0
    buffer_load_dwordx4 v13, s[48:51], s33 offen lds
    s_add_u32 s33, s33, 1024
    s_add_u32 m0, s31, 20480
    s_nop 0
    buffer_load_dwordx4 v13, s[48:51], s32 offen lds
    s_add_u32 s32, s32, 1024
    s_add_u32 m0, s31, 21504
    s_nop 0
    buffer_load_dwordx4 v13, s[48:51], s33 offen lds
    s_add_u32 s33, s33, 1024
    s_add_u32 m0, s31, 22528
    s_nop 0
    buffer_load_dwordx4 v13, s[48:51], s32 offen lds
    s_add_u32 s32, s32, 1024
    s_add_u32 m0, s31, 23552
    s_nop 0
    buffer_load_dwordx4 v13, s[48:51], s33 offen lds
    s_add_u32 s33, s33, 1024
    s_add_u32 m0, s31, 24576
    s_nop 0
    buffer_load_dwordx4 v13, s[48:51], s32 offen lds
    s_add_u32 s32, s32, 1024
    s_add_u32 m0, s31, 25600
    s_nop 0
    buffer_load_dwordx4 v13, s[48:51], s33 offen lds
    s_add_u32 s33, s33, 1024
    s_add_u32 m0, s31, 26624
    s_nop 0
    buffer_load_dwordx4 v13, s[48:51], s32 offen lds
    s_add_u32 s32, s32, 1024
    s_add_u32 m0, s31, 27648
    s_nop 0
    buffer_load_dwordx4 v13, s[48:51], s33 offen lds
    s_add_u32 s33, s33, 1024
    s_add_u32 m0, s31, 28672
    s_nop 0
    buffer_load_dwordx4 v13, s[48:51], s32 offen lds
    s_add_u32 s32, s32, 1024
    s_add_u32 m0, s31, 29696
    s_nop 0
    buffer_load_dwordx4 v13, s[48:51], s33 offen lds
    s_add_u32 s33, s33, 1024
    s_lshl_b32 s44, s11, 3
    s_add_u32 s44, s44, 13557760
    v_mov_b32 v4, s44
    s_lshl_b32 s44, s30, 8
    s_add_u32 s44, s44, 13549568
    v_lshl_add_u32 v9, v2, 3, s44
    v_cmp_gt_u32 vcc, 32, v2
    s_nop 1
    v_cndmask_b32 v9, v4, v9, vcc
    s_mov_b32 s40, s20
    s_mov_b32 s41, s21
    s_mov_b32 s42, 0x200000
    s_mov_b32 s43, 0x00020000
    s_lshl_b32 s32, s10, 17
    s_lshl_b32 s33, s11, 6
    s_add_u32 s32, s32, s33
    s_add_u32 s32, s32, 11403264
    s_add_u32 s33, s32, 65536
    v_lshrrev_b32 v4, 2, v2
    v_lshlrev_b32 v4, 12, v4
    v_and_b32 v5, 3, v2
    v_lshl_add_u32 v4, v5, 4, v4
    v_and_b32 v6, 31, v2
    v_lshlrev_b32 v7, 2, v6
    s_lshl_b32 s34, s11, 7
    s_add_u32 s34, s34, 13500416
    s_lshl_b32 s35, s3, 11
    s_add_u32 s35, s35, 73728
    v_lshrrev_b32 v14, 5, v2
    v_bfe_u32 v15, v2, 2, 2
    v_lshl_add_u32 v15, v14, 2, v15
    v_lshlrev_b32 v15, 6, v15
    v_bfe_u32 v1, v2, 4, 1
    v_lshl_add_u32 v15, v1, 5, v15
    v_lshl_add_u32 v15, v5, 3, v15
    v_add_u32 v15, s35, v15
    v_lshlrev_b32 v6, 10, v6
    v_lshl_add_u32 v6, v14, 4, v6
    s_lshl_b32 s36, s11, 15
    s_lshl_b32 s37, s10, 6
    s_add_u32 s36, s36, s37
    s_lshr_b32 s44, s28, 1
    s_lshl_b32 s44, s44, 7
    s_add_u32 s44, s44, 13551616
    v_lshl_add_u32 v5, v2, 3, s44
    v_add_u32 v12, s31, v3
    s_setprio 0
    s_cmp_lg_u32 s3, 0
    s_cbranch_scc1 Lg2_w
    s_cmp_ge_u32 s2, 240
    s_cbranch_scc1 Lsp_ok
    s_lshl_b32 s44, s2, 7
    s_add_u32 s44, s44, 13516800
    s_mov_b32 s62, 24
Lsp:
    s_load_dword s45, s[48:49], s44 glc
    s_waitcnt lgkmcnt(0)
    s_cmp_eq_u32 s45, s60
    s_cbranch_scc1 Lsp_ok
    s_sleep 2
    s_sub_u32 s62, s62, 1
    s_cbranch_scc0 Lsp
Lsp_ok:
    s_mov_b32 s62, 1048576
    s_mov_b64 exec, 32767
    s_branch Lpoll_h_in
Lpoll_h:
    s_sleep 2
Lpoll_h_in:
    buffer_load_dwordx2 v[0:1], v5, s[48:51], 0 offen sc1
    s_waitcnt vmcnt(0)
    v_cmp_ne_u64 vcc, s[60:61], v[0:1]
    s_sub_u32 s62, s62, 1
    s_cbranch_scc1 Lpoll_h_ok
    s_nop 0
    s_cbranch_vccnz Lpoll_h
Lpoll_h_ok:
    s_mov_b64 exec, -1
Lg2_w:
    s_barrier
    s_setprio 3
    buffer_load_dwordx4 v[160:163], v3, s[48:51], s26 offen offset:0
    buffer_load_dwordx4 v[164:167], v3, s[48:51], s27 offen offset:0
    buffer_load_dwordx4 v[168:171], v3, s[48:51], s26 offen offset:1024
    buffer_load_dwordx4 v[172:175], v3, s[48:51], s27 offen offset:1024
    buffer_load_dwordx4 v[176:179], v3, s[48:51], s26 offen offset:2048
    buffer_load_dwordx4 v[180:183], v3, s[48:51], s27 offen offset:2048
    buffer_load_dwordx4 v[184:187], v3, s[48:51], s26 offen offset:3072
    buffer_load_dwordx4 v[188:191], v3, s[48:51], s27 offen offset:3072
    s_add_u32 s26, s26, 4096
    s_add_u32 s27, s27, 4096
    buffer_load_dwordx4 v[192:195], v3, s[48:51], s26 offen offset:0
    buffer_load_dwordx4 v[196:199], v3, s[48:51], s27 offen offset:0
    buffer_load_dwordx4 v[200:203], v3, s[48:51], s26 offen offset:1024
    buffer_load_dwordx4 v[204:207], v3, s[48:51], s27 offen offset:1024
    buffer_load_dwordx4 v[208:211], v3, s[48:51], s26 offen offset:2048
    buffer_load_dwordx4 v[212:215], v3, s[48:51], s27 offen offset:2048
    buffer_load_dwordx4 v[216:219], v3, s[48:51], s26 offen offset:3072
    buffer_load_dwordx4 v[220:223], v3, s[48:51], s27 offen offset:3072
    s_add_u32 s26, s26, 4096
    s_add_u32 s27, s27, 4096
    buffer_load_dwordx4 v[16:19], v3, s[48:51], s26 offen offset:0
    buffer_load_dwordx4 v[20:23], v3, s[48:51], s27 offen offset:0
    buffer_load_dwordx2 v[0:1], v9, s[48:51], 0 offen sc1
    s_waitcnt vmcnt(17)
    v_mfma_f32_32x32x16_bf16 v[96:111], v[24:27], v[160:163], 0
    v_mfma_f32_32x32x16_bf16 v[112:127], v[24:27], v[164:167], 0
    v_mfma_f32_32x32x16_bf16 v[128:143], v[28:31], v[160:163], 0
    v_mfma_f32_32x32x16_bf16 v[144:159], v[28:31], v[164:167], 0
    buffer_load_dwordx4 v[160:163], v3, s[48:51], s26 offen offset:1024
    buffer_load_dwordx4 v[164:167], v3, s[48:51], s27 offen offset:1024
    ds_read_b128 v[24:27], v11 offset:0
    ds_read_b128 v[28:31], v11 offset:1024
    s_waitcnt vmcnt(17)
    v_mfma_f32_32x32x16_bf16 v[96:111], v[32:35], v[168:171], v[96:111]
    v_mfma_f32_32x32x16_bf16 v[112:127], v[32:35], v[172:175], v[112:127]
    v_mfma_f32_32x32x16_bf16 v[128:143], v[36:39], v[168:171], v[128:143]
    v_mfma_f32_32x32x16_bf16 v[144:159], v[36:39], v[172:175], v[144:159]
    buffer_load_dwordx4 v[168:171], v3, s[48:51], s26 offen offset:2048
    buffer_load_dwordx4 v[172:175], v3, s[48:51], s27 offen offset:2048
    ds_read_b128 v[32:35], v11 offset:2048
    ds_read_b128 v[36:39], v11 offset:3072
    s_waitcnt vmcnt(17)
    v_mfma_f32_32x32x16_bf16 v[96:111], v[40:43], v[176:179], v[96:111]
    v_mfma_f32_32x32x16_bf16 v[112:127], v[40:43], v[180:183], v[112:127]
    v_mfma_f32_32x32x16_bf16 v[128:143], v[44:47], v[176:179], v[128:143]
    v_mfma_f32_32x32x16_bf16 v[144:159], v[44:47], v[180:183], v[144:159]
    buffer_load_dwordx4 v[176:179], v3, s[48:51], s26 offen offset:3072
    buffer_load_dwordx4 v[180:183], v3, s[48:51], s27 offen offset:3072
    s_add_u32 s26, s26, 4096
    s_add_u32 s27, s27, 4096
    ds_read_b128 v[40:43], v12 offset:16384
    ds_read_b128 v[44:47], v12 offset:17408
    s_waitcnt vmcnt(17)
    v_mfma_f32_32x32x16_bf16 v[96:111], v[48:51], v[184:187], v[96:111]
    v_mfma_f32_32x32x16_bf16 v[112:127], v[48:51], v[188:191], v[112:127]
    v_mfma_f32_32x32x16_bf16 v[128:143], v[52:55], v[184:187], v[128:143]
    v_mfma_f32_32x32x16_bf16 v[144:159], v[52:55], v[188:191], v[144:159]
    buffer_load_dwordx4 v[184:187], v3, s[48:51], s26 offen offset:0
    buffer_load_dwordx4 v[188:191], v3, s[48:51], s27 offen offset:0
    ds_read_b128 v[48:51], v12 offset:18432
    ds_read_b128 v[52:55], v12 offset:19456
    s_waitcnt vmcnt(17)
    v_mfma_f32_32x32x16_bf16 v[96:111], v[56:59], v[192:195], v[96:111]
    v_mfma_f32_32x32x16_bf16 v[112:127], v[56:59], v[196:199], v[112:127]
    v_mfma_f32_32x32x16_bf16 v[128:143], v[60:63], v[192:195], v[128:143]
    v_mfma_f32_32x32x16_bf16 v[144:159], v[60:63], v[196:199], v[144:159]
    buffer_load_dwordx4 v[192:195], v3, s[48:51], s26 offen offset:1024
    buffer_load_dwordx4 v[196:199], v3, s[48:51], s27 offen offset:1024
    ds_read_b128 v[56:59], v12 offset:20480
    ds_read_b128 v[60:63], v12 offset:21504
    s_waitcnt vmcnt(17)
    v_mfma_f32_32x32x16_bf16 v[96:111], v[224:227], v[200:203], v[96:111]
    v_mfma_f32_32x32x16_bf16 v[112:127], v[224:227], v[204:207], v[112:127]
    v_mfma_f32_32x32x16_bf16 v[128:143], v[228:231], v[200:203], v[128:143]
    v_mfma_f32_32x32x16_bf16 v[144:159], v[228:231], v[204:207], v[144:159]
    buffer_load_dwordx4 v[200:203], v3, s[48:51], s26 offen offset:2048
    buffer_load_dwordx4 v[204:207], v3, s[48:51], s27 offen offset:2048
    ds_read_b128 v[224:227], v12 offset:22528
    ds_read_b128 v[228:231], v12 offset:23552
    s_waitcnt vmcnt(17)
    v_mfma_f32_32x32x16_bf16 v[96:111], v[232:235], v[208:211], v[96:111]
    v_mfma_f32_32x32x16_bf16 v[112:127], v[232:235], v[212:215], v[112:127]
    v_mfma_f32_32x32x16_bf16 v[128:143], v[236:239], v[208:211], v[128:143]
    v_mfma_f32_32x32x16_bf16 v[144:159], v[236:239], v[212:215], v[144:159]
    buffer_load_dwordx4 v[208:211], v3, s[48:51], s26 offen offset:3072
    buffer_load_dwordx4 v[212:215], v3, s[48:51], s27 offen offset:3072
    s_add_u32 s26, s26, 4096
    s_add_u32 s27, s27, 4096
    ds_read_b128 v[232:235], v12 offset:24576
    ds_read_b128 v[236:239], v12 offset:25600
    s_waitcnt vmcnt(17)
    v_mfma_f32_32x32x16_bf16 v[96:111], v[240:243], v[216:219], v[96:111]
    v_mfma_f32_32x32x16_bf16 v[112:127], v[240:243], v[220:223], v[112:127]
    v_mfma_f32_32x32x16_bf16 v[128:143], v[244:247], v[216:219], v[128:143]
    v_mfma_f32_32x32x16_bf16 v[144:159], v[244:247], v[220:223], v[144:159]
    buffer_load_dwordx4 v[216:219], v3, s[48:51], s26 offen offset:0
    buffer_load_dwordx4 v[220:223], v3, s[48:51], s27 offen offset:0
    ds_read_b128 v[240:243], v12 offset:26624
    ds_read_b128 v[244:247], v12 offset:27648
    s_waitcnt vmcnt(17)
    v_mfma_f32_32x32x16_bf16 v[96:111], v[248:251], v[16:19], v[96:111]
    v_mfma_f32_32x32x16_bf16 v[112:127], v[248:251], v[20:23], v[112:127]
    v_mfma_f32_32x32x16_bf16 v[128:143], v[252:255], v[16:19], v[128:143]
    v_mfma_f32_32x32x16_bf16 v[144:159], v[252:255], v[20:23], v[144:159]
    buffer_load_dwordx4 v[16:19], v3, s[48:51], s26 offen offset:1024
    buffer_load_dwordx4 v[20:23], v3, s[48:51], s27 offen offset:1024
    ds_read_b128 v[248:251], v12 offset:28672
    ds_read_b128 v[252:255], v12 offset:29696
    s_waitcnt vmcnt(16)
    v_mfma_f32_32x32x16_bf16 v[96:111], v[64:67], v[160:163], v[96:111]
    v_mfma_f32_32x32x16_bf16 v[112:127], v[64:67], v[164:167], v[112:127]
    v_mfma_f32_32x32x16_bf16 v[128:143], v[68:71], v[160:163], v[128:143]
    v_mfma_f32_32x32x16_bf16 v[144:159], v[68:71], v[164:167], v[144:159]
    v_cmp_ne_u64 vcc, s[60:61], v[0:1]
    s_nop 1
    s_cbranch_vccz Lpoll_l_ok
    s_mov_b32 s62, 1048576
    s_mov_b64 exec, -1
    s_branch Lpoll_l_in
Lpoll_l:
    s_sleep 8
Lpoll_l_in:
    buffer_load_dwordx2 v[0:1], v9, s[48:51], 0 offen sc1
    s_waitcnt vmcnt(0)
    v_cmp_ne_u64 vcc, s[60:61], v[0:1]
    s_sub_u32 s62, s62, 1
    s_cbranch_scc1 Lpoll_l_ok
    s_nop 0
    s_cbranch_vccnz Lpoll_l
Lpoll_l_ok:
    s_mov_b64 exec, -1
    s_mov_b32 m0, s35
    s_nop 0
    buffer_load_dwordx4 v4, s[48:51], s32 offen lds
    s_add_u32 m0, s35, 1024
    s_nop 0
    buffer_load_dwordx4 v4, s[48:51], s33 offen lds
    buffer_load_dword v8, v7, s[48:51], s34 offen sc1
    buffer_load_dwordx4 v[160:163], v3, s[48:51], s26 offen offset:2048
    buffer_load_dwordx4 v[164:167], v3, s[48:51], s27 offen offset:2048
    s_waitcnt vmcnt(19)
    v_mfma_f32_32x32x16_bf16 v[96:111], v[72:75], v[168:171], v[96:111]
    v_mfma_f32_32x32x16_bf16 v[112:127], v[72:75], v[172:175], v[112:127]
    v_mfma_f32_32x32x16_bf16 v[128:143], v[76:79], v[168:171], v[128:143]
    v_mfma_f32_32x32x16_bf16 v[144:159], v[76:79], v[172:175], v[144:159]
    buffer_load_dwordx4 v[168:171], v3, s[48:51], s26 offen offset:3072
    buffer_load_dwordx4 v[172:175], v3, s[48:51], s27 offen offset:3072
    s_add_u32 s26, s26, 4096
    s_add_u32 s27, s27, 4096
    s_waitcnt vmcnt(19)
    v_mfma_f32_32x32x16_bf16 v[96:111], v[80:83], v[176:179], v[96:111]
    v_mfma_f32_32x32x16_bf16 v[112:127], v[80:83], v[180:183], v[112:127]
    v_mfma_f32_32x32x16_bf16 v[128:143], v[84:87], v[176:179], v[128:143]
    v_mfma_f32_32x32x16_bf16 v[144:159], v[84:87], v[180:183], v[144:159]
    buffer_load_dwordx4 v[176:179], v3, s[48:51], s26 offen offset:0
    buffer_load_dwordx4 v[180:183], v3, s[48:51], s27 offen offset:0
    s_waitcnt vmcnt(19)
    v_mfma_f32_32x32x16_bf16 v[96:111], v[88:91], v[184:187], v[96:111]
    v_mfma_f32_32x32x16_bf16 v[112:127], v[88:91], v[188:191], v[112:127]
    v_mfma_f32_32x32x16_bf16 v[128:143], v[92:95], v[184:187], v[128:143]
    v_mfma_f32_32x32x16_bf16 v[144:159], v[92:95], v[188:191], v[144:159]
    buffer_load_dwordx4 v[184:187], v3, s[48:51], s26 offen offset:1024
    buffer_load_dwordx4 v[188:191], v3, s[48:51], s27 offen offset:1024
    s_waitcnt vmcnt(19) lgkmcnt(0)
    v_mfma_f32_32x32x16_bf16 v[96:111], v[24:27], v[192:195], v[96:111]
    v_mfma_f32_32x32x16_bf16 v[112:127], v[24:27], v[196:199], v[112:127]
    v_mfma_f32_32x32x16_bf16 v[128:143], v[28:31], v[192:195], v[128:143]
    v_mfma_f32_32x32x16_bf16 v[144:159], v[28:31], v[196:199], v[144:159]
    s_waitcnt vmcnt(17)
    v_mfma_f32_32x32x16_bf16 v[96:111], v[32:35], v[200:203], v[96:111]
    v_mfma_f32_32x32x16_bf16 v[112:127], v[32:35], v[204:207], v[112:127]
    v_mfma_f32_32x32x16_bf16 v[128:143], v[36:39], v[200:203], v[128:143]
    v_mfma_f32_32x32x16_bf16 v[144:159], v[36:39], v[204:207], v[144:159]
    s_waitcnt vmcnt(15)
    v_mfma_f32_32x32x16_bf16 v[96:111], v[40:43], v[208:211], v[96:111]
    v_mfma_f32_32x32x16_bf16 v[112:127], v[40:43], v[212:215], v[112:127]
    v_mfma_f32_32x32x16_bf16 v[128:143], v[44:47], v[208:211], v[128:143]
    v_mfma_f32_32x32x16_bf16 v[144:159], v[44:47], v[212:215], v[144:159]
    s_waitcnt vmcnt(13)
    v_mfma_f32_32x32x16_bf16 v[96:111], v[48:51], v[216:219], v[96:111]
    v_mfma_f32_32x32x16_bf16 v[112:127], v[48:51], v[220:223], v[112:127]
    v_mfma_f32_32x32x16_bf16 v[128:143], v[52:55], v[216:219], v[128:143]
    v_mfma_f32_32x32x16_bf16 v[144:159], v[52:55], v[220:223], v[144:159]
    s_waitcnt vmcnt(11)
    v_mfma_f32_32x32x16_bf16 v[96:111], v[56:59], v[16:19], v[96:111]
    v_mfma_f32_32x32x16_bf16 v[112:127], v[56:59], v[20:23], v[112:127]
    v_mfma_f32_32x32x16_bf16 v[128:143], v[60:63], v[16:19], v[128:143]
    v_mfma_f32_32x32x16_bf16 v[144:159], v[60:63], v[20:23], v[144:159]
    s_waitcnt vmcnt(6)
    v_mfma_f32_32x32x16_bf16 v[96:111], v[224:227], v[160:163], v[96:111]
    v_mfma_f32_32x32x16_bf16 v[112:127], v[224:227], v[164:167], v[112:127]
    v_mfma_f32_32x32x16_bf16 v[128:143], v[228:231], v[160:163], v[128:143]
    v_mfma_f32_32x32x16_bf16 v[144:159], v[228:231], v[164:167], v[144:159]
    s_waitcnt vmcnt(4)
    v_mfma_f32_32x32x16_bf16 v[96:111], v[232:235], v[168:171], v[96:111]
    v_mfma_f32_32x32x16_bf16 v[112:127], v[232:235], v[172:175], v[112:127]
    v_mfma_f32_32x32x16_bf16 v[128:143], v[236:239], v[168:171], v[128:143]
    v_mfma_f32_32x32x16_bf16 v[144:159], v[236:239], v[172:175], v[144:159]
    s_waitcnt vmcnt(2)
    v_mfma_f32_32x32x16_bf16 v[96:111], v[240:243], v[176:179], v[96:111]
    v_mfma_f32_32x32x16_bf16 v[112:127], v[240:243], v[180:183], v[112:127]
    v_mfma_f32_32x32x16_bf16 v[128:143], v[244:247], v[176:179], v[128:143]
    v_mfma_f32_32x32x16_bf16 v[144:159], v[244:247], v[180:183], v[144:159]
    s_waitcnt vmcnt(0)
    v_mfma_f32_32x32x16_bf16 v[96:111], v[248:251], v[184:187], v[96:111]
    v_mfma_f32_32x32x16_bf16 v[112:127], v[248:251], v[188:191], v[112:127]
    v_mfma_f32_32x32x16_bf16 v[128:143], v[252:255], v[184:187], v[128:143]
    v_mfma_f32_32x32x16_bf16 v[144:159], v[252:255], v[188:191], v[144:159]
    v_sub_f32 v9, 1.0, v8
    v_cvt_pk_bf16_f32 v9, v9, v9
    v_lshlrev_b32 v9, 16, v9
    s_xor_b32 s44, s3, 1
    s_mul_i32 s44, s44, 14336
    s_add_u32 s44, s44, 16384
    v_add_u32 v1, s44, v3
    s_xor_b32 s44, s3, 2
    s_mul_i32 s44, s44, 14336
    s_add_u32 s44, s44, 20480
    v_add_u32 v2, s44, v3
    s_xor_b32 s44, s3, 3
    s_mul_i32 s44, s44, 14336
    s_add_u32 s44, s44, 24576
    v_add_u32 v4, s44, v3
    ds_write_b128 v12, v[112:115] offset:16384
    ds_write_b128 v12, v[116:119] offset:17408
    ds_write_b128 v12, v[120:123] offset:18432
    ds_write_b128 v12, v[124:127] offset:19456
    ds_write_b128 v12, v[128:131] offset:20480
    ds_write_b128 v12, v[132:135] offset:21504
    ds_write_b128 v12, v[136:139] offset:22528
    ds_write_b128 v12, v[140:143] offset:23552
    ds_write_b128 v12, v[144:147] offset:24576
    ds_write_b128 v12, v[148:151] offset:25600
    ds_write_b128 v12, v[152:155] offset:26624
    ds_write_b128 v12, v[156:159] offset:27648
    ds_read_b64_tr_b16 v[80:81], v15 offset:0
    ds_read_b64_tr_b16 v[82:83], v15 offset:512
    ds_read_b64_tr_b16 v[84:85], v15 offset:1024
    ds_read_b64_tr_b16 v[86:87], v15 offset:1536
    s_waitcnt lgkmcnt(0)
    s_barrier
    ds_read_b128 v[160:163], v1 offset:0
    ds_read_b128 v[164:167], v1 offset:1024
    ds_read_b128 v[168:171], v1 offset:2048
    ds_read_b128 v[172:175], v1 offset:3072
    ds_read_b128 v[176:179], v2 offset:0
    ds_read_b128 v[180:183], v2 offset:1024
    ds_read_b128 v[184:187], v2 offset:2048
    ds_read_b128 v[188:191], v2 offset:3072
    ds_read_b128 v[192:195], v4 offset:0
    ds_read_b128 v[196:199], v4 offset:1024
    ds_read_b128 v[200:203], v4 offset:2048
    ds_read_b128 v[204:207], v4 offset:3072
    v_lshlrev_b32 v24, 16, v80
    v_and_b32 v25, s54, v80
    v_pk_mul_f32 v[24:25], v[24:25], v[8:9] op_sel_hi:[1,0]
    v_lshlrev_b32 v26, 16, v81
    v_and_b32 v27, s54, v81
    v_pk_mul_f32 v[26:27], v[26:27], v[8:9] op_sel_hi:[1,0]
    v_lshlrev_b32 v28, 16, v82
    v_and_b32 v29, s54, v82
    v_pk_mul_f32 v[28:29], v[28:29], v[8:9] op_sel_hi:[1,0]
    v_lshlrev_b32 v30, 16, v83
    v_and_b32 v31, s54, v83
    v_pk_mul_f32 v[30:31], v[30:31], v[8:9] op_sel_hi:[1,0]
    v_lshlrev_b32 v32, 16, v84
    v_and_b32 v33, s54, v84
    v_pk_mul_f32 v[32:33], v[32:33], v[8:9] op_sel_hi:[1,0]
    v_lshlrev_b32 v34, 16, v85
    v_and_b32 v35, s54, v85
    v_pk_mul_f32 v[34:35], v[34:35], v[8:9] op_sel_hi:[1,0]
    v_lshlrev_b32 v36, 16, v86
    v_and_b32 v37, s54, v86
    v_pk_mul_f32 v[36:37], v[36:37], v[8:9] op_sel_hi:[1,0]
    v_lshlrev_b32 v38, 16, v87
    v_and_b32 v39, s54, v87
    v_pk_mul_f32 v[38:39], v[38:39], v[8:9] op_sel_hi:[1,0]
    s_waitcnt lgkmcnt(8)
    v_pk_add_f32 v[96:97], v[96:97], v[160:161]
    v_pk_add_f32 v[98:99], v[98:99], v[162:163]
    v_pk_add_f32 v[100:101], v[100:101], v[164:165]
    v_pk_add_f32 v[102:103], v[102:103], v[166:167]
    v_pk_add_f32 v[104:105], v[104:105], v[168:169]
    v_pk_add_f32 v[106:107], v[106:107], v[170:171]
    v_pk_add_f32 v[108:109], v[108:109], v[172:173]
    v_pk_add_f32 v[110:111], v[110:111], v[174:175]
    s_waitcnt lgkmcnt(4)
    v_pk_add_f32 v[96:97], v[96:97], v[176:177]
    v_pk_add_f32 v[98:99], v[98:99], v[178:179]
    v_pk_add_f32 v[100:101], v[100:101], v[180:181]
    v_pk_add_f32 v[102:103], v[102:103], v[182:183]
    v_pk_add_f32 v[104:105], v[104:105], v[184:185]
    v_pk_add_f32 v[106:107], v[106:107], v[186:187]
    v_pk_add_f32 v[108:109], v[108:109], v[188:189]
    v_pk_add_f32 v[110:111], v[110:111], v[190:191]
    s_waitcnt lgkmcnt(0)
    v_pk_add_f32 v[96:97], v[96:97], v[192:193]
    v_pk_add_f32 v[98:99], v[98:99], v[194:195]
    v_pk_add_f32 v[100:101], v[100:101], v[196:197]
    v_pk_add_f32 v[102:103], v[102:103], v[198:199]
    v_pk_add_f32 v[104:105], v[104:105], v[200:201]
    v_pk_add_f32 v[106:107], v[106:107], v[202:203]
    v_pk_add_f32 v[108:109], v[108:109], v[204:205]
    v_pk_add_f32 v[110:111], v[110:111], v[206:207]
    v_pk_fma_f32 v[24:25], v[96:97], v[8:9], v[24:25] op_sel:[0,1,0] op_sel_hi:[1,1,1]
    v_pk_fma_f32 v[26:27], v[98:99], v[8:9], v[26:27] op_sel:[0,1,0] op_sel_hi:[1,1,1]
    v_pk_fma_f32 v[28:29], v[100:101], v[8:9], v[28:29] op_sel:[0,1,0] op_sel_hi:[1,1,1]
    v_pk_fma_f32 v[30:31], v[102:103], v[8:9], v[30:31] op_sel:[0,1,0] op_sel_hi:[1,1,1]
    v_pk_fma_f32 v[32:33], v[104:105], v[8:9], v[32:33] op_sel:[0,1,0] op_sel_hi:[1,1,1]
    v_pk_fma_f32 v[34:35], v[106:107], v[8:9], v[34:35] op_sel:[0,1,0] op_sel_hi:[1,1,1]
    v_pk_fma_f32 v[36:37], v[108:109], v[8:9], v[36:37] op_sel:[0,1,0] op_sel_hi:[1,1,1]
    v_pk_fma_f32 v[38:39], v[110:111], v[8:9], v[38:39] op_sel:[0,1,0] op_sel_hi:[1,1,1]
    v_cvt_pk_bf16_f32 v88, v24, v25
    v_cvt_pk_bf16_f32 v89, v26, v27
    v_cvt_pk_bf16_f32 v90, v28, v29
    v_cvt_pk_bf16_f32 v91, v30, v31
    v_cvt_pk_bf16_f32 v92, v32, v33
    v_cvt_pk_bf16_f32 v93, v34, v35
    v_cvt_pk_bf16_f32 v94, v36, v37
    v_cvt_pk_bf16_f32 v95, v38, v39
    v_permlane32_swap_b32 v88, v90
    v_permlane32_swap_b32 v89, v91
    buffer_store_dwordx4 v[88:91], v6, s[40:43], s36 offen offset:0
    v_permlane32_swap_b32 v92, v94
    v_permlane32_swap_b32 v93, v95
    buffer_store_dwordx4 v[92:95], v6, s[40:43], s36 offen offset:32
    s_endpgm
Lk1_b:
    s_cmp_ge_u32 s2, 496
    s_cbranch_scc1 Lk1_x
    s_setprio 2
    s_load_dwordx2 s[16:17], s[0:1], 0
    s_load_dwordx4 s[20:23], s[0:1], 80
    s_load_dwordx4 s[24:27], s[0:1], 120
    v_lshrrev_b32 v56, 6, v0
    v_and_b32 v57, 63, v0
    v_readfirstlane_b32 s3, v56
    s_and_b32 s4, s2, 7
    s_sub_u32 s5, s2, 256
    s_lshr_b32 s5, s5, 3
    s_mul_i32 s4, s4, 30
    s_add_u32 s4, s4, s5
    s_cmp_ge_u32 s4, 120
    s_cselect_b32 s5, 8, 0
    s_cselect_b32 s6, 120, 0
    s_sub_u32 s4, s4, s6
    s_lshr_b32 s6, s4, 3
    s_and_b32 s4, s4, 7
    s_add_u32 s5, s5, s4
    s_lshr_b32 s7, s3, 1
    s_and_b32 s8, s3, 1
    s_lshl_b32 s9, s5, 17
    s_lshl_b32 s10, s3, 15
    s_add_u32 s9, s9, s10
    v_lshrrev_b32 v58, 3, v57
    v_lshlrev_b32 v58, 10, v58
    v_add_u32 v58, s9, v58
    v_lshrrev_b32 v59, 4, v57
    v_and_b32 v60, 7, v57
    v_xor_b32 v61, v60, v59
    v_lshl_add_u32 v11, v61, 4, v58
    v_xor_b32 v61, 4, v61
    v_lshl_add_u32 v12, v61, 4, v58
    v_add_u32 v12, 0x2000, v12
    v_add_u32 v13, 0x4000, v11
    v_add_u32 v14, 0x4000, v12
    s_mul_i32 s9, s8, 192
    s_mul_i32 s10, s6, 192
    s_lshl_b32 s11, s7, 1
    v_add_u32 v58, s9, v57
    v_add_u32 v58, 0, v58
    v_mul_u32_u24 v60, 43691, v58
    v_lshrrev_b32 v60, 19, v60
    v_mul_u32_u24 v61, 12, v60
    v_sub_u32 v61, v58, v61
    v_xor_b32 v61, s11, v61
    v_mul_u32_u24 v60, 2752, v60
    v_lshl_add_u32 v60, v61, 4, v60
    v_add_u32 v8, s10, v60
    v_add_u32 v58, s9, v57
    v_add_u32 v58, 64, v58
    v_mul_u32_u24 v60, 43691, v58
    v_lshrrev_b32 v60, 19, v60
    v_mul_u32_u24 v61, 12, v60
    v_sub_u32 v61, v58, v61
    v_xor_b32 v61, s11, v61
    v_mul_u32_u24 v60, 2752, v60
    v_lshl_add_u32 v60, v61, 4, v60
    v_add_u32 v9, s10, v60
    v_add_u32 v58, s9, v57
    v_add_u32 v58, 128, v58
    v_mul_u32_u24 v60, 43691, v58
    v_lshrrev_b32 v60, 19, v60
    v_mul_u32_u24 v61, 12, v60
    v_sub_u32 v61, v58, v61
    v_xor_b32 v61, s11, v61
    v_mul_u32_u24 v60, 2752, v60
    v_lshl_add_u32 v60, v61, 4, v60
    v_add_u32 v10, s10, v60
    s_waitcnt lgkmcnt(0)
    s_mov_b32 s28, s16
    s_mov_b32 s29, s17
    s_mov_b32 s30, 0x200000
    s_mov_b32 s31, 0x00020000
    s_cmp_eq_u32 s7, 0
    s_cselect_b32 s32, s20, s22
    s_cselect_b32 s33, s21, s23
    s_mov_b32 s34, 1409024
    s_mov_b32 s35, 0x00020000
    s_mov_b32 s36, s26
    s_mov_b32 s37, s27
    s_mov_b32 s38, 0xd70000
    s_mov_b32 s39, 0x00020000
    s_lshl_b32 s12, s3, 12
    s_mul_i32 s13, s3, 3072
    s_add_u32 s13, s13, 32768
    s_mul_i32 s14, s5, 0
    s_mul_i32 s15, s6, 0
    s_add_u32 s14, s14, s15
    s_and_b32 s14, s14, 7
    s_mul_i32 s15, s14, 176128
    s_lshl_b32 s14, s14, 7
    s_add_u32 m0, s12, 0
    s_nop 0
    buffer_load_dwordx4 v11, s[28:31], s14 offen lds
    s_add_u32 m0, s12, 1024
    s_nop 0
    buffer_load_dwordx4 v12, s[28:31], s14 offen lds
    s_add_u32 m0, s12, 2048
    s_nop 0
    buffer_load_dwordx4 v13, s[28:31], s14 offen lds
    s_add_u32 m0, s12, 3072
    s_nop 0
    buffer_load_dwordx4 v14, s[28:31], s14 offen lds
    s_add_u32 s14, s14, 128
    s_and_b32 s14, s14, 1023
    s_add_u32 m0, s13, 0
    s_nop 0
    buffer_load_dwordx4 v8, s[32:35], s15 offen lds
    s_add_u32 m0, s13, 1024
    s_nop 0
    buffer_load_dwordx4 v9, s[32:35], s15 offen lds
    s_add_u32 m0, s13, 2048
    s_nop 0
    buffer_load_dwordx4 v10, s[32:35], s15 offen lds
    s_add_u32 s15, s15, 88064
    s_cmp_eq_u32 s15, 1409024
    s_cselect_b32 s15, 0, s15
    s_add_u32 m0, s13, 12288
    s_nop 0
    buffer_load_dwordx4 v8, s[32:35], s15 offen lds
    s_add_u32 m0, s13, 13312
    s_nop 0
    buffer_load_dwordx4 v9, s[32:35], s15 offen lds
    s_add_u32 m0, s13, 14336
    s_nop 0
    buffer_load_dwordx4 v10, s[32:35], s15 offen lds
    s_add_u32 s15, s15, 88064
    s_cmp_eq_u32 s15, 1409024
    s_cselect_b32 s15, 0, s15
    s_add_u32 m0, s13, 24576
    s_nop 0
    buffer_load_dwordx4 v8, s[32:35], s15 offen lds
    s_add_u32 m0, s13, 25600
    s_nop 0
    buffer_load_dwordx4 v9, s[32:35], s15 offen lds
    s_add_u32 m0, s13, 26624
    s_nop 0
    buffer_load_dwordx4 v10, s[32:35], s15 offen lds
    s_add_u32 s15, s15, 88064
    s_cmp_eq_u32 s15, 1409024
    s_cselect_b32 s15, 0, s15
    s_add_u32 m0, s12, 16384
    s_nop 0
    buffer_load_dwordx4 v11, s[28:31], s14 offen lds
    s_add_u32 m0, s12, 17408
    s_nop 0
    buffer_load_dwordx4 v12, s[28:31], s14 offen lds
    s_add_u32 m0, s12, 18432
    s_nop 0
    buffer_load_dwordx4 v13, s[28:31], s14 offen lds
    s_add_u32 m0, s12, 19456
    s_nop 0
    buffer_load_dwordx4 v14, s[28:31], s14 offen lds
    s_add_u32 s14, s14, 128
    s_and_b32 s14, s14, 1023
    s_add_u32 m0, s13, 36864
    s_nop 0
    buffer_load_dwordx4 v8, s[32:35], s15 offen lds
    s_add_u32 m0, s13, 37888
    s_nop 0
    buffer_load_dwordx4 v9, s[32:35], s15 offen lds
    s_add_u32 m0, s13, 38912
    s_nop 0
    buffer_load_dwordx4 v10, s[32:35], s15 offen lds
    s_add_u32 s15, s15, 88064
    s_cmp_eq_u32 s15, 1409024
    s_cselect_b32 s15, 0, s15
    v_and_b32 v58, 31, v57
    v_lshrrev_b32 v59, 5, v57
    v_lshrrev_b32 v60, 1, v58
    v_and_b32 v60, 7, v60
    v_xor_b32 v60, v60, v59
    s_lshl_b32 s9, s7, 13
    v_lshlrev_b32 v58, 7, v58
    v_add_u32 v58, s9, v58
    v_xor_b32 v61, 0, v60
    v_lshl_add_u32 v4, v61, 4, v58
    v_xor_b32 v61, 2, v60
    v_lshl_add_u32 v5, v61, 4, v58
    v_xor_b32 v61, 4, v60
    v_lshl_add_u32 v6, v61, 4, v58
    v_xor_b32 v61, 6, v60
    v_lshl_add_u32 v7, v61, 4, v58
    v_bfe_u32 v58, v57, 4, 1
    v_bfe_u32 v60, v57, 2, 2
    v_lshl_add_u32 v60, v59, 3, v60
    v_mul_u32_u24 v60, 192, v60
    v_mul_u32_u24 v61, 6144, v58
    v_add_u32 v60, v60, v61
    v_and_b32 v61, 3, v57
    v_lshl_add_u32 v60, v61, 3, v60
    v_add_u32 v60, 32768, v60
    s_mul_i32 s9, s8, 3
    s_add_u32 s10, s9, 0
    v_xor_b32 v61, s10, v58
    v_lshl_add_u32 v1, v61, 5, v60
    s_add_u32 s10, s9, 1
    v_xor_b32 v61, s10, v58
    v_lshl_add_u32 v2, v61, 5, v60
    s_add_u32 s10, s9, 2
    v_xor_b32 v61, s10, v58
    v_lshl_add_u32 v3, v61, 5, v60
    v_lshlrev_b32 v15, 4, v57
    v_mov_b32 v64, 0
    v_mov_b32 v65, 0
    v_mov_b32 v66, 0
    v_mov_b32 v67, 0
    v_mov_b32 v68, 0
    v_mov_b32 v69, 0
    v_mov_b32 v70, 0
    v_mov_b32 v71, 0
    v_mov_b32 v72, 0
    v_mov_b32 v73, 0
    v_mov_b32 v74, 0
    v_mov_b32 v75, 0
    v_mov_b32 v76, 0
    v_mov_b32 v77, 0
    v_mov_b32 v78, 0
    v_mov_b32 v79, 0
    v_mov_b32 v80, 0
    v_mov_b32 v81, 0
    v_mov_b32 v82, 0
    v_mov_b32 v83, 0
    v_mov_b32 v84, 0
    v_mov_b32 v85, 0
    v_mov_b32 v86, 0
    v_mov_b32 v87, 0
    v_mov_b32 v88, 0
    v_mov_b32 v89, 0
    v_mov_b32 v90, 0
    v_mov_b32 v91, 0
    v_mov_b32 v92, 0
    v_mov_b32 v93, 0
    v_mov_b32 v94, 0
    v_mov_b32 v95, 0
    v_mov_b32 v96, 0
    v_mov_b32 v97, 0
    v_mov_b32 v98, 0
    v_mov_b32 v99, 0
    v_mov_b32 v100, 0
    v_mov_b32 v101, 0
    v_mov_b32 v102, 0
    v_mov_b32 v103, 0
    v_mov_b32 v104, 0
    v_mov_b32 v105, 0
    v_mov_b32 v106, 0
    v_mov_b32 v107, 0
    v_mov_b32 v108, 0
    v_mov_b32 v109, 0
    v_mov_b32 v110, 0
    v_mov_b32 v111, 0
    v_mov_b32 v112, 0
    v_mov_b32 v113, 0
    v_mov_b32 v114, 0
    v_mov_b32 v115, 0
    v_mov_b32 v116, 0
    v_mov_b32 v117, 0
    v_mov_b32 v118, 0
    v_mov_b32 v119, 0
    v_mov_b32 v120, 0
    v_mov_b32 v121, 0
    v_mov_b32 v122, 0
    v_mov_b32 v123, 0
    v_mov_b32 v124, 0
    v_mov_b32 v125, 0
    v_mov_b32 v126, 0
    v_mov_b32 v127, 0
    v_mov_b32 v128, 0
    v_mov_b32 v129, 0
    v_mov_b32 v130, 0
    v_mov_b32 v131, 0
    v_mov_b32 v132, 0
    v_mov_b32 v133, 0
    v_mov_b32 v134, 0
    v_mov_b32 v135, 0
    v_mov_b32 v136, 0
    v_mov_b32 v137, 0
    v_mov_b32 v138, 0
    v_mov_b32 v139, 0
    v_mov_b32 v140, 0
    v_mov_b32 v141, 0
    v_mov_b32 v142, 0
    v_mov_b32 v143, 0
    v_mov_b32 v144, 0
    v_mov_b32 v145, 0
    v_mov_b32 v146, 0
    v_mov_b32 v147, 0
    v_mov_b32 v148, 0
    v_mov_b32 v149, 0
    v_mov_b32 v150, 0
    v_mov_b32 v151, 0
    v_mov_b32 v152, 0
    v_mov_b32 v153, 0
    v_mov_b32 v154, 0
    v_mov_b32 v155, 0
    v_mov_b32 v156, 0
    v_mov_b32 v157, 0
    v_mov_b32 v158, 0
    v_mov_b32 v159, 0
    s_setprio 1
    s_waitcnt vmcnt(13)
    s_barrier
    ds_read_b128 v[28:31], v4 offset:0
    ds_read_b64_tr_b16 v[16:17], v1 offset:0
    ds_read_b64_tr_b16 v[18:19], v1 offset:768
    ds_read_b64_tr_b16 v[20:21], v2 offset:0
    ds_read_b64_tr_b16 v[22:23], v2 offset:768
    ds_read_b64_tr_b16 v[24:25], v3 offset:0
    ds_read_b64_tr_b16 v[26:27], v3 offset:768
    ds_read_b128 v[32:35], v4 offset:4096
    s_mov_b32 s40, 3
Lg1_loop:
    s_waitcnt lgkmcnt(0)
    v_mfma_f32_32x32x16_bf16 v[64:79], v[16:19], v[28:31], v[64:79]
    ds_read_b128 v[48:51], v5 offset:0
    ds_read_b64_tr_b16 v[36:37], v1 offset:3072
    ds_read_b64_tr_b16 v[38:39], v1 offset:3840
    v_mfma_f32_32x32x16_bf16 v[96:111], v[20:23], v[28:31], v[96:111]
    ds_read_b64_tr_b16 v[40:41], v2 offset:3072
    ds_read_b64_tr_b16 v[42:43], v2 offset:3840
    ds_read_b64_tr_b16 v[44:45], v3 offset:3072
    v_mfma_f32_32x32x16_bf16 v[128:143], v[24:27], v[28:31], v[128:143]
    ds_read_b64_tr_b16 v[46:47], v3 offset:3840
    ds_read_b128 v[52:55], v5 offset:4096
    v_mfma_f32_32x32x16_bf16 v[80:95], v[16:19], v[32:35], v[80:95]
    v_mfma_f32_32x32x16_bf16 v[112:127], v[20:23], v[32:35], v[112:127]
    v_mfma_f32_32x32x16_bf16 v[144:159], v[24:27], v[32:35], v[144:159]
    s_waitcnt lgkmcnt(0) vmcnt(10)
    s_barrier
    v_mfma_f32_32x32x16_bf16 v[64:79], v[36:39], v[48:51], v[64:79]
    ds_read_b128 v[28:31], v6 offset:0
    ds_read_b64_tr_b16 v[16:17], v1 offset:12288
    ds_read_b64_tr_b16 v[18:19], v1 offset:13056
    v_mfma_f32_32x32x16_bf16 v[96:111], v[40:43], v[48:51], v[96:111]
    ds_read_b64_tr_b16 v[20:21], v2 offset:12288
    ds_read_b64_tr_b16 v[22:23], v2 offset:13056
    ds_read_b64_tr_b16 v[24:25], v3 offset:12288
    v_mfma_f32_32x32x16_bf16 v[128:143], v[44:47], v[48:51], v[128:143]
    ds_read_b64_tr_b16 v[26:27], v3 offset:13056
    ds_read_b128 v[32:35], v6 offset:4096
    s_add_u32 m0, s13, 0
    s_nop 0
    buffer_load_dwordx4 v8, s[32:35], s15 offen lds
    v_mfma_f32_32x32x16_bf16 v[80:95], v[36:39], v[52:55], v[80:95]
    s_add_u32 m0, s13, 1024
    s_nop 0
    buffer_load_dwordx4 v9, s[32:35], s15 offen lds
    s_add_u32 m0, s13, 2048
    s_nop 0
    buffer_load_dwordx4 v10, s[32:35], s15 offen lds
    s_add_u32 s15, s15, 88064
    s_cmp_eq_u32 s15, 1409024
    s_cselect_b32 s15, 0, s15
    v_mfma_f32_32x32x16_bf16 v[112:127], v[40:43], v[52:55], v[112:127]
    v_mfma_f32_32x32x16_bf16 v[144:159], v[44:47], v[52:55], v[144:159]
    s_waitcnt lgkmcnt(0)
    v_mfma_f32_32x32x16_bf16 v[64:79], v[16:19], v[28:31], v[64:79]
    ds_read_b128 v[48:51], v7 offset:0
    ds_read_b64_tr_b16 v[36:37], v1 offset:15360
    ds_read_b64_tr_b16 v[38:39], v1 offset:16128
    v_mfma_f32_32x32x16_bf16 v[96:111], v[20:23], v[28:31], v[96:111]
    ds_read_b64_tr_b16 v[40:41], v2 offset:15360
    ds_read_b64_tr_b16 v[42:43], v2 offset:16128
    ds_read_b64_tr_b16 v[44:45], v3 offset:15360
    v_mfma_f32_32x32x16_bf16 v[128:143], v[24:27], v[28:31], v[128:143]
    ds_read_b64_tr_b16 v[46:47], v3 offset:16128
    ds_read_b128 v[52:55], v7 offset:4096
    v_mfma_f32_32x32x16_bf16 v[80:95], v[16:19], v[32:35], v[80:95]
    v_mfma_f32_32x32x16_bf16 v[112:127], v[20:23], v[32:35], v[112:127]
    v_mfma_f32_32x32x16_bf16 v[144:159], v[24:27], v[32:35], v[144:159]
    s_waitcnt lgkmcnt(0) vmcnt(6)
    s_barrier
    v_mfma_f32_32x32x16_bf16 v[64:79], v[36:39], v[48:51], v[64:79]
    ds_read_b128 v[28:31], v4 offset:16384
    ds_read_b64_tr_b16 v[16:17], v1 offset:24576
    ds_read_b64_tr_b16 v[18:19], v1 offset:25344
    v_mfma_f32_32x32x16_bf16 v[96:111], v[40:43], v[48:51], v[96:111]
    ds_read_b64_tr_b16 v[20:21], v2 offset:24576
    ds_read_b64_tr_b16 v[22:23], v2 offset:25344
    ds_read_b64_tr_b16 v[24:25], v3 offset:24576
    v_mfma_f32_32x32x16_bf16 v[128:143], v[44:47], v[48:51], v[128:143]
    ds_read_b64_tr_b16 v[26:27], v3 offset:25344
    ds_read_b128 v[32:35], v4 offset:20480
    s_add_u32 m0, s12, 0
    s_nop 0
    buffer_load_dwordx4 v11, s[28:31], s14 offen lds
    v_mfma_f32_32x32x16_bf16 v[80:95], v[36:39], v[52:55], v[80:95]
    s_add_u32 m0, s12, 1024
    s_nop 0
    buffer_load_dwordx4 v12, s[28:31], s14 offen lds
    s_add_u32 m0, s12, 2048
    s_nop 0
    buffer_load_dwordx4 v13, s[28:31], s14 offen lds
    v_mfma_f32_32x32x16_bf16 v[112:127], v[40:43], v[52:55], v[112:127]
    s_add_u32 m0, s12, 3072
    s_nop 0
    buffer_load_dwordx4 v14, s[28:31], s14 offen lds
    s_add_u32 s14, s14, 128
    s_and_b32 s14, s14, 1023
    s_add_u32 m0, s13, 12288
    s_nop 0
    buffer_load_dwordx4 v8, s[32:35], s15 offen lds
    v_mfma_f32_32x32x16_bf16 v[144:159], v[44:47], v[52:55], v[144:159]
    s_add_u32 m0, s13, 13312
    s_nop 0
    buffer_load_dwordx4 v9, s[32:35], s15 offen lds
    s_add_u32 m0, s13, 14336
    s_nop 0
    buffer_load_dwordx4 v10, s[32:35], s15 offen lds
    s_add_u32 s15, s15, 88064
    s_cmp_eq_u32 s15, 1409024
    s_cselect_b32 s15, 0, s15
    s_waitcnt lgkmcnt(0)
    v_mfma_f32_32x32x16_bf16 v[64:79], v[16:19], v[28:31], v[64:79]
    ds_read_b128 v[48:51], v5 offset:16384
    ds_read_b64_tr_b16 v[36:37], v1 offset:27648
    ds_read_b64_tr_b16 v[38:39], v1 offset:28416
    v_mfma_f32_32x32x16_bf16 v[96:111], v[20:23], v[28:31], v[96:111]
    ds_read_b64_tr_b16 v[40:41], v2 offset:27648
    ds_read_b64_tr_b16 v[42:43], v2 offset:28416
    ds_read_b64_tr_b16 v[44:45], v3 offset:27648
    v_mfma_f32_32x32x16_bf16 v[128:143], v[24:27], v[28:31], v[128:143]
    ds_read_b64_tr_b16 v[46:47], v3 offset:28416
    ds_read_b128 v[52:55], v5 offset:20480
    v_mfma_f32_32x32x16_bf16 v[80:95], v[16:19], v[32:35], v[80:95]
    v_mfma_f32_32x32x16_bf16 v[112:127], v[20:23], v[32:35], v[112:127]
    v_mfma_f32_32x32x16_bf16 v[144:159], v[24:27], v[32:35], v[144:159]
    s_waitcnt lgkmcnt(0) vmcnt(10)
    s_barrier
    v_mfma_f32_32x32x16_bf16 v[64:79], v[36:39], v[48:51], v[64:79]
    ds_read_b128 v[28:31], v6 offset:16384
    ds_read_b64_tr_b16 v[16:17], v1 offset:36864
    ds_read_b64_tr_b16 v[18:19], v1 offset:37632
    v_mfma_f32_32x32x16_bf16 v[96:111], v[40:43], v[48:51], v[96:111]
    ds_read_b64_tr_b16 v[20:21], v2 offset:36864
    ds_read_b64_tr_b16 v[22:23], v2 offset:37632
    ds_read_b64_tr_b16 v[24:25], v3 offset:36864
    v_mfma_f32_32x32x16_bf16 v[128:143], v[44:47], v[48:51], v[128:143]
    ds_read_b64_tr_b16 v[26:27], v3 offset:37632
    ds_read_b128 v[32:35], v6 offset:20480
    s_add_u32 m0, s13, 24576
    s_nop 0
    buffer_load_dwordx4 v8, s[32:35], s15 offen lds
    v_mfma_f32_32x32x16_bf16 v[80:95], v[36:39], v[52:55], v[80:95]
    s_add_u32 m0, s13, 25600
    s_nop 0
    buffer_load_dwordx4 v9, s[32:35], s15 offen lds
    s_add_u32 m0, s13, 26624
    s_nop 0
    buffer_load_dwordx4 v10, s[32:35], s15 offen lds
    s_add_u32 s15, s15, 88064
    s_cmp_eq_u32 s15, 1409024
    s_cselect_b32 s15, 0, s15
    v_mfma_f32_32x32x16_bf16 v[112:127], v[40:43], v[52:55], v[112:127]
    v_mfma_f32_32x32x16_bf16 v[144:159], v[44:47], v[52:55], v[144:159]
    s_waitcnt lgkmcnt(0)
    v_mfma_f32_32x32x16_bf16 v[64:79], v[16:19], v[28:31], v[64:79]
    ds_read_b128 v[48:51], v7 offset:16384
    ds_read_b64_tr_b16 v[36:37], v1 offset:39936
    ds_read_b64_tr_b16 v[38:39], v1 offset:40704
    v_mfma_f32_32x32x16_bf16 v[96:111], v[20:23], v[28:31], v[96:111]
    ds_read_b64_tr_b16 v[40:41], v2 offset:39936
    ds_read_b64_tr_b16 v[42:43], v2 offset:40704
    ds_read_b64_tr_b16 v[44:45], v3 offset:39936
    v_mfma_f32_32x32x16_bf16 v[128:143], v[24:27], v[28:31], v[128:143]
    ds_read_b64_tr_b16 v[46:47], v3 offset:40704
    ds_read_b128 v[52:55], v7 offset:20480
    v_mfma_f32_32x32x16_bf16 v[80:95], v[16:19], v[32:35], v[80:95]
    v_mfma_f32_32x32x16_bf16 v[112:127], v[20:23], v[32:35], v[112:127]
    v_mfma_f32_32x32x16_bf16 v[144:159], v[24:27], v[32:35], v[144:159]
    s_waitcnt lgkmcnt(0) vmcnt(6)
    s_barrier
    v_mfma_f32_32x32x16_bf16 v[64:79], v[36:39], v[48:51], v[64:79]
    ds_read_b128 v[28:31], v4 offset:0
    ds_read_b64_tr_b16 v[16:17], v1 offset:0
    ds_read_b64_tr_b16 v[18:19], v1 offset:768
    v_mfma_f32_32x32x16_bf16 v[96:111], v[40:43], v[48:51], v[96:111]
    ds_read_b64_tr_b16 v[20:21], v2 offset:0
    ds_read_b64_tr_b16 v[22:23], v2 offset:768
    ds_read_b64_tr_b16 v[24:25], v3 offset:0
    v_mfma_f32_32x32x16_bf16 v[128:143], v[44:47], v[48:51], v[128:143]
    ds_read_b64_tr_b16 v[26:27], v3 offset:768
    ds_read_b128 v[32:35], v4 offset:4096
    s_add_u32 m0, s12, 16384
    s_nop 0
    buffer_load_dwordx4 v11, s[28:31], s14 offen lds
    v_mfma_f32_32x32x16_bf16 v[80:95], v[36:39], v[52:55], v[80:95]
    s_add_u32 m0, s12, 17408
    s_nop 0
    buffer_load_dwordx4 v12, s[28:31], s14 offen lds
    s_add_u32 m0, s12, 18432
    s_nop 0
    buffer_load_dwordx4 v13, s[28:31], s14 offen lds
    v_mfma_f32_32x32x16_bf16 v[112:127], v[40:43], v[52:55], v[112:127]
    s_add_u32 m0, s12, 19456
    s_nop 0
    buffer_load_dwordx4 v14, s[28:31], s14 offen lds
    s_add_u32 s14, s14, 128
    s_and_b32 s14, s14, 1023
    s_add_u32 m0, s13, 36864
    s_nop 0
    buffer_load_dwordx4 v8, s[32:35], s15 offen lds
    v_mfma_f32_32x32x16_bf16 v[144:159], v[44:47], v[52:55], v[144:159]
    s_add_u32 m0, s13, 37888
    s_nop 0
    buffer_load_dwordx4 v9, s[32:35], s15 offen lds
    s_add_u32 m0, s13, 38912
    s_nop 0
    buffer_load_dwordx4 v10, s[32:35], s15 offen lds
    s_add_u32 s15, s15, 88064
    s_cmp_eq_u32 s15, 1409024
    s_cselect_b32 s15, 0, s15
    s_sub_u32 s40, s40, 1
    s_cmp_lg_u32 s40, 0
    s_cbranch_scc1 Lg1_loop
    v_mov_b32 v162, 0
    global_load_dwordx2 v[160:161], v162, s[24:25]
    s_waitcnt lgkmcnt(0)
    v_mfma_f32_32x32x16_bf16 v[64:79], v[16:19], v[28:31], v[64:79]
    ds_read_b128 v[48:51], v5 offset:0
    ds_read_b64_tr_b16 v[36:37], v1 offset:3072
    ds_read_b64_tr_b16 v[38:39], v1 offset:3840
    v_mfma_f32_32x32x16_bf16 v[96:111], v[20:23], v[28:31], v[96:111]
    ds_read_b64_tr_b16 v[40:41], v2 offset:3072
    ds_read_b64_tr_b16 v[42:43], v2 offset:3840
    ds_read_b64_tr_b16 v[44:45], v3 offset:3072
    v_mfma_f32_32x32x16_bf16 v[128:143], v[24:27], v[28:31], v[128:143]
    ds_read_b64_tr_b16 v[46:47], v3 offset:3840
    ds_read_b128 v[52:55], v5 offset:4096
    v_mfma_f32_32x32x16_bf16 v[80:95], v[16:19], v[32:35], v[80:95]
    v_mfma_f32_32x32x16_bf16 v[112:127], v[20:23], v[32:35], v[112:127]
    v_mfma_f32_32x32x16_bf16 v[144:159], v[24:27], v[32:35], v[144:159]
    s_waitcnt lgkmcnt(0) vmcnt(11)
    s_barrier
    v_mfma_f32_32x32x16_bf16 v[64:79], v[36:39], v[48:51], v[64:79]
    ds_read_b128 v[28:31], v6 offset:0
    ds_read_b64_tr_b16 v[16:17], v1 offset:12288
    ds_read_b64_tr_b16 v[18:19], v1 offset:13056
    v_mfma_f32_32x32x16_bf16 v[96:111], v[40:43], v[48:51], v[96:111]
    ds_read_b64_tr_b16 v[20:21], v2 offset:12288
    ds_read_b64_tr_b16 v[22:23], v2 offset:13056
    ds_read_b64_tr_b16 v[24:25], v3 offset:12288
    v_mfma_f32_32x32x16_bf16 v[128:143], v[44:47], v[48:51], v[128:143]
    ds_read_b64_tr_b16 v[26:27], v3 offset:13056
    ds_read_b128 v[32:35], v6 offset:4096
    v_mfma_f32_32x32x16_bf16 v[80:95], v[36:39], v[52:55], v[80:95]
    v_mfma_f32_32x32x16_bf16 v[112:127], v[40:43], v[52:55], v[112:127]
    v_mfma_f32_32x32x16_bf16 v[144:159], v[44:47], v[52:55], v[144:159]
    s_waitcnt lgkmcnt(0)
    v_mfma_f32_32x32x16_bf16 v[64:79], v[16:19], v[28:31], v[64:79]
    ds_read_b128 v[48:51], v7 offset:0
    ds_read_b64_tr_b16 v[36:37], v1 offset:15360
    ds_read_b64_tr_b16 v[38:39], v1 offset:16128
    v_mfma_f32_32x32x16_bf16 v[96:111], v[20:23], v[28:31], v[96:111]
    ds_read_b64_tr_b16 v[40:41], v2 offset:15360
    ds_read_b64_tr_b16 v[42:43], v2 offset:16128
    ds_read_b64_tr_b16 v[44:45], v3 offset:15360
    v_mfma_f32_32x32x16_bf16 v[128:143], v[24:27], v[28:31], v[128:143]
    ds_read_b64_tr_b16 v[46:47], v3 offset:16128
    ds_read_b128 v[52:55], v7 offset:4096
    v_mfma_f32_32x32x16_bf16 v[80:95], v[16:19], v[32:35], v[80:95]
    v_mfma_f32_32x32x16_bf16 v[112:127], v[20:23], v[32:35], v[112:127]
    v_mfma_f32_32x32x16_bf16 v[144:159], v[24:27], v[32:35], v[144:159]
    s_waitcnt lgkmcnt(0) vmcnt(4)
    s_barrier
    v_mfma_f32_32x32x16_bf16 v[64:79], v[36:39], v[48:51], v[64:79]
    ds_read_b128 v[28:31], v4 offset:16384
    ds_read_b64_tr_b16 v[16:17], v1 offset:24576
    ds_read_b64_tr_b16 v[18:19], v1 offset:25344
    v_mfma_f32_32x32x16_bf16 v[96:111], v[40:43], v[48:51], v[96:111]
    ds_read_b64_tr_b16 v[20:21], v2 offset:24576
    ds_read_b64_tr_b16 v[22:23], v2 offset:25344
    ds_read_b64_tr_b16 v[24:25], v3 offset:24576
    v_mfma_f32_32x32x16_bf16 v[128:143], v[44:47], v[48:51], v[128:143]
    ds_read_b64_tr_b16 v[26:27], v3 offset:25344
    ds_read_b128 v[32:35], v4 offset:20480
    v_mfma_f32_32x32x16_bf16 v[80:95], v[36:39], v[52:55], v[80:95]
    v_mfma_f32_32x32x16_bf16 v[112:127], v[40:43], v[52:55], v[112:127]
    v_mfma_f32_32x32x16_bf16 v[144:159], v[44:47], v[52:55], v[144:159]
    s_waitcnt lgkmcnt(0)
    v_mfma_f32_32x32x16_bf16 v[64:79], v[16:19], v[28:31], v[64:79]
    ds_read_b128 v[48:51], v5 offset:16384
    ds_read_b64_tr_b16 v[36:37], v1 offset:27648
    ds_read_b64_tr_b16 v[38:39], v1 offset:28416
    v_mfma_f32_32x32x16_bf16 v[96:111], v[20:23], v[28:31], v[96:111]
    ds_read_b64_tr_b16 v[40:41], v2 offset:27648
    ds_read_b64_tr_b16 v[42:43], v2 offset:28416
    ds_read_b64_tr_b16 v[44:45], v3 offset:27648
    v_mfma_f32_32x32x16_bf16 v[128:143], v[24:27], v[28:31], v[128:143]
    ds_read_b64_tr_b16 v[46:47], v3 offset:28416
    ds_read_b128 v[52:55], v5 offset:20480
    v_mfma_f32_32x32x16_bf16 v[80:95], v[16:19], v[32:35], v[80:95]
    v_mfma_f32_32x32x16_bf16 v[112:127], v[20:23], v[32:35], v[112:127]
    v_mfma_f32_32x32x16_bf16 v[144:159], v[24:27], v[32:35], v[144:159]
    s_waitcnt lgkmcnt(0) vmcnt(1)
    s_barrier
    v_mfma_f32_32x32x16_bf16 v[64:79], v[36:39], v[48:51], v[64:79]
    ds_read_b128 v[28:31], v6 offset:16384
    ds_read_b64_tr_b16 v[16:17], v1 offset:36864
    ds_read_b64_tr_b16 v[18:19], v1 offset:37632
    v_mfma_f32_32x32x16_bf16 v[96:111], v[40:43], v[48:51], v[96:111]
    ds_read_b64_tr_b16 v[20:21], v2 offset:36864
    ds_read_b64_tr_b16 v[22:23], v2 offset:37632
    ds_read_b64_tr_b16 v[24:25], v3 offset:36864
    v_mfma_f32_32x32x16_bf16 v[128:143], v[44:47], v[48:51], v[128:143]
    ds_read_b64_tr_b16 v[26:27], v3 offset:37632
    ds_read_b128 v[32:35], v6 offset:20480
    v_mfma_f32_32x32x16_bf16 v[80:95], v[36:39], v[52:55], v[80:95]
    v_mfma_f32_32x32x16_bf16 v[112:127], v[40:43], v[52:55], v[112:127]
    v_mfma_f32_32x32x16_bf16 v[144:159], v[44:47], v[52:55], v[144:159]
    s_waitcnt lgkmcnt(0)
    v_mfma_f32_32x32x16_bf16 v[64:79], v[16:19], v[28:31], v[64:79]
    ds_read_b128 v[48:51], v7 offset:16384
    ds_read_b64_tr_b16 v[36:37], v1 offset:39936
    ds_read_b64_tr_b16 v[38:39], v1 offset:40704
    v_mfma_f32_32x32x16_bf16 v[96:111], v[20:23], v[28:31], v[96:111]
    ds_read_b64_tr_b16 v[40:41], v2 offset:39936
    ds_read_b64_tr_b16 v[42:43], v2 offset:40704
    ds_read_b64_tr_b16 v[44:45], v3 offset:39936
    v_mfma_f32_32x32x16_bf16 v[128:143], v[24:27], v[28:31], v[128:143]
    ds_read_b64_tr_b16 v[46:47], v3 offset:40704
    ds_read_b128 v[52:55], v7 offset:20480
    v_mfma_f32_32x32x16_bf16 v[80:95], v[16:19], v[32:35], v[80:95]
    v_mfma_f32_32x32x16_bf16 v[112:127], v[20:23], v[32:35], v[112:127]
    v_mfma_f32_32x32x16_bf16 v[144:159], v[24:27], v[32:35], v[144:159]
    s_waitcnt lgkmcnt(0)
    v_mfma_f32_32x32x16_bf16 v[64:79], v[36:39], v[48:51], v[64:79]
    v_mfma_f32_32x32x16_bf16 v[96:111], v[40:43], v[48:51], v[96:111]
    v_mfma_f32_32x32x16_bf16 v[128:143], v[44:47], v[48:51], v[128:143]
    v_mfma_f32_32x32x16_bf16 v[80:95], v[36:39], v[52:55], v[80:95]
    v_mfma_f32_32x32x16_bf16 v[112:127], v[40:43], v[52:55], v[112:127]
    v_mfma_f32_32x32x16_bf16 v[144:159], v[44:47], v[52:55], v[144:159]
    v_mov_b32 v56, 0xc0135761
    v_mov_b32 v57, 0xc0135761
    v_mov_b32 v58, 1.0
    v_mov_b32 v59, 1.0
    s_mov_b32 s42, 0xbdd2d3e8
    s_mov_b32 s43, 0xbdd2d3e8
    s_lshl_b32 s9, s5, 2
    s_lshl_b32 s10, s7, 1
    s_add_u32 s9, s9, s10
    s_mul_i32 s9, s9, 88
    s_mul_i32 s10, s6, 6
    s_mul_i32 s11, s8, 3
    s_add_u32 s10, s10, s11
    s_add_u32 s9, s9, s10
    s_lshl_b32 s9, s9, 10
    s_add_u32 s11, s9, 90112
    s_cmp_ge_u32 s10, 88
    s_cbranch_scc1 Lg1_done
    v_pk_mul_f32 v[16:17], v[64:65], v[64:65]
    v_pk_mul_f32 v[18:19], v[66:67], v[66:67]
    v_pk_mul_f32 v[20:21], v[68:69], v[68:69]
    v_pk_mul_f32 v[22:23], v[70:71], v[70:71]
    v_pk_fma_f32 v[16:17], v[16:17], s[42:43], v[56:57]
    v_pk_fma_f32 v[18:19], v[18:19], s[42:43], v[56:57]
    v_pk_fma_f32 v[20:21], v[20:21], s[42:43], v[56:57]
    v_pk_fma_f32 v[22:23], v[22:23], s[42:43], v[56:57]
    v_pk_mul_f32 v[16:17], v[16:17], v[64:65]
    v_pk_mul_f32 v[18:19], v[18:19], v[66:67]
    v_pk_mul_f32 v[20:21], v[20:21], v[68:69]
    v_pk_mul_f32 v[22:23], v[22:23], v[70:71]
    v_exp_f32 v16, v16
    v_exp_f32 v17, v17
    v_exp_f32 v18, v18
    v_exp_f32 v19, v19
    v_exp_f32 v20, v20
    v_exp_f32 v21, v21
    v_exp_f32 v22, v22
    v_exp_f32 v23, v23
    v_pk_mul_f32 v[64:65], v[64:65], v[72:73]
    v_pk_mul_f32 v[66:67], v[66:67], v[74:75]
    v_pk_mul_f32 v[68:69], v[68:69], v[76:77]
    v_pk_mul_f32 v[70:71], v[70:71], v[78:79]
    v_pk_add_f32 v[16:17], v[16:17], v[58:59]
    v_pk_add_f32 v[18:19], v[18:19], v[58:59]
    v_pk_add_f32 v[20:21], v[20:21], v[58:59]
    v_pk_add_f32 v[22:23], v[22:23], v[58:59]
    v_rcp_f32 v16, v16
    v_rcp_f32 v17, v17
    v_rcp_f32 v18, v18
    v_rcp_f32 v19, v19
    v_rcp_f32 v20, v20
    v_rcp_f32 v21, v21
    v_rcp_f32 v22, v22
    v_rcp_f32 v23, v23
    v_pk_mul_f32 v[64:65], v[64:65], v[16:17]
    v_pk_mul_f32 v[66:67], v[66:67], v[18:19]
    v_pk_mul_f32 v[68:69], v[68:69], v[20:21]
    v_pk_mul_f32 v[70:71], v[70:71], v[22:23]
    v_cvt_pk_bf16_f32 v32, v64, v65
    v_cvt_pk_bf16_f32 v33, v66, v67
    v_cvt_pk_bf16_f32 v34, v68, v69
    v_cvt_pk_bf16_f32 v35, v70, v71
    buffer_store_dwordx4 v[32:35], v15, s[36:39], s9 offen offset:0 sc1
    v_pk_mul_f32 v[24:25], v[80:81], v[80:81]
    v_pk_mul_f32 v[26:27], v[82:83], v[82:83]
    v_pk_mul_f32 v[28:29], v[84:85], v[84:85]
    v_pk_mul_f32 v[30:31], v[86:87], v[86:87]
    v_pk_fma_f32 v[24:25], v[24:25], s[42:43], v[56:57]
    v_pk_fma_f32 v[26:27], v[26:27], s[42:43], v[56:57]
    v_pk_fma_f32 v[28:29], v[28:29], s[42:43], v[56:57]
    v_pk_fma_f32 v[30:31], v[30:31], s[42:43], v[56:57]
    v_pk_mul_f32 v[24:25], v[24:25], v[80:81]
    v_pk_mul_f32 v[26:27], v[26:27], v[82:83]
    v_pk_mul_f32 v[28:29], v[28:29], v[84:85]
    v_pk_mul_f32 v[30:31], v[30:31], v[86:87]
    v_exp_f32 v24, v24
    v_exp_f32 v25, v25
    v_exp_f32 v26, v26
    v_exp_f32 v27, v27
    v_exp_f32 v28, v28
    v_exp_f32 v29, v29
    v_exp_f32 v30, v30
    v_exp_f32 v31, v31
    v_pk_mul_f32 v[80:81], v[80:81], v[88:89]
    v_pk_mul_f32 v[82:83], v[82:83], v[90:91]
    v_pk_mul_f32 v[84:85], v[84:85], v[92:93]
    v_pk_mul_f32 v[86:87], v[86:87], v[94:95]
    v_pk_add_f32 v[24:25], v[24:25], v[58:59]
    v_pk_add_f32 v[26:27], v[26:27], v[58:59]
    v_pk_add_f32 v[28:29], v[28:29], v[58:59]
    v_pk_add_f32 v[30:31], v[30:31], v[58:59]
    v_rcp_f32 v24, v24
    v_rcp_f32 v25, v25
    v_rcp_f32 v26, v26
    v_rcp_f32 v27, v27
    v_rcp_f32 v28, v28
    v_rcp_f32 v29, v29
    v_rcp_f32 v30, v30
    v_rcp_f32 v31, v31
    v_pk_mul_f32 v[80:81], v[80:81], v[24:25]
    v_pk_mul_f32 v[82:83], v[82:83], v[26:27]
    v_pk_mul_f32 v[84:85], v[84:85], v[28:29]
    v_pk_mul_f32 v[86:87], v[86:87], v[30:31]
    v_cvt_pk_bf16_f32 v36, v80, v81
    v_cvt_pk_bf16_f32 v37, v82, v83
    v_cvt_pk_bf16_f32 v38, v84, v85
    v_cvt_pk_bf16_f32 v39, v86, v87
    buffer_store_dwordx4 v[36:39], v15, s[36:39], s11 offen offset:0 sc1
    s_cmp_ge_u32 s10, 87
    s_cbranch_scc1 Lg1_done
    v_pk_mul_f32 v[16:17], v[96:97], v[96:97]
    v_pk_mul_f32 v[18:19], v[98:99], v[98:99]
    v_pk_mul_f32 v[20:21], v[100:101], v[100:101]
    v_pk_mul_f32 v[22:23], v[102:103], v[102:103]
    v_pk_fma_f32 v[16:17], v[16:17], s[42:43], v[56:57]
    v_pk_fma_f32 v[18:19], v[18:19], s[42:43], v[56:57]
    v_pk_fma_f32 v[20:21], v[20:21], s[42:43], v[56:57]
    v_pk_fma_f32 v[22:23], v[22:23], s[42:43], v[56:57]
    v_pk_mul_f32 v[16:17], v[16:17], v[96:97]
    v_pk_mul_f32 v[18:19], v[18:19], v[98:99]
    v_pk_mul_f32 v[20:21], v[20:21], v[100:101]
    v_pk_mul_f32 v[22:23], v[22:23], v[102:103]
    v_exp_f32 v16, v16
    v_exp_f32 v17, v17
    v_exp_f32 v18, v18
    v_exp_f32 v19, v19
    v_exp_f32 v20, v20
    v_exp_f32 v21, v21
    v_exp_f32 v22, v22
    v_exp_f32 v23, v23
    v_pk_mul_f32 v[96:97], v[96:97], v[104:105]
    v_pk_mul_f32 v[98:99], v[98:99], v[106:107]
    v_pk_mul_f32 v[100:101], v[100:101], v[108:109]
    v_pk_mul_f32 v[102:103], v[102:103], v[110:111]
    v_pk_add_f32 v[16:17], v[16:17], v[58:59]
    v_pk_add_f32 v[18:19], v[18:19], v[58:59]
    v_pk_add_f32 v[20:21], v[20:21], v[58:59]
    v_pk_add_f32 v[22:23], v[22:23], v[58:59]
    v_rcp_f32 v16, v16
    v_rcp_f32 v17, v17
    v_rcp_f32 v18, v18
    v_rcp_f32 v19, v19
    v_rcp_f32 v20, v20
    v_rcp_f32 v21, v21
    v_rcp_f32 v22, v22
    v_rcp_f32 v23, v23
    v_pk_mul_f32 v[96:97], v[96:97], v[16:17]
    v_pk_mul_f32 v[98:99], v[98:99], v[18:19]
    v_pk_mul_f32 v[100:101], v[100:101], v[20:21]
    v_pk_mul_f32 v[102:103], v[102:103], v[22:23]
    v_cvt_pk_bf16_f32 v40, v96, v97
    v_cvt_pk_bf16_f32 v41, v98, v99
    v_cvt_pk_bf16_f32 v42, v100, v101
    v_cvt_pk_bf16_f32 v43, v102, v103
    buffer_store_dwordx4 v[40:43], v15, s[36:39], s9 offen offset:1024 sc1
    v_pk_mul_f32 v[24:25], v[112:113], v[112:113]
    v_pk_mul_f32 v[26:27], v[114:115], v[114:115]
    v_pk_mul_f32 v[28:29], v[116:117], v[116:117]
    v_pk_mul_f32 v[30:31], v[118:119], v[118:119]
    v_pk_fma_f32 v[24:25], v[24:25], s[42:43], v[56:57]
    v_pk_fma_f32 v[26:27], v[26:27], s[42:43], v[56:57]
    v_pk_fma_f32 v[28:29], v[28:29], s[42:43], v[56:57]
    v_pk_fma_f32 v[30:31], v[30:31], s[42:43], v[56:57]
    v_pk_mul_f32 v[24:25], v[24:25], v[112:113]
    v_pk_mul_f32 v[26:27], v[26:27], v[114:115]
    v_pk_mul_f32 v[28:29], v[28:29], v[116:117]
    v_pk_mul_f32 v[30:31], v[30:31], v[118:119]
    v_exp_f32 v24, v24
    v_exp_f32 v25, v25
    v_exp_f32 v26, v26
    v_exp_f32 v27, v27
    v_exp_f32 v28, v28
    v_exp_f32 v29, v29
    v_exp_f32 v30, v30
    v_exp_f32 v31, v31
    v_pk_mul_f32 v[112:113], v[112:113], v[120:121]
    v_pk_mul_f32 v[114:115], v[114:115], v[122:123]
    v_pk_mul_f32 v[116:117], v[116:117], v[124:125]
    v_pk_mul_f32 v[118:119], v[118:119], v[126:127]
    v_pk_add_f32 v[24:25], v[24:25], v[58:59]
    v_pk_add_f32 v[26:27], v[26:27], v[58:59]
    v_pk_add_f32 v[28:29], v[28:29], v[58:59]
    v_pk_add_f32 v[30:31], v[30:31], v[58:59]
    v_rcp_f32 v24, v24
    v_rcp_f32 v25, v25
    v_rcp_f32 v26, v26
    v_rcp_f32 v27, v27
    v_rcp_f32 v28, v28
    v_rcp_f32 v29, v29
    v_rcp_f32 v30, v30
    v_rcp_f32 v31, v31
    v_pk_mul_f32 v[112:113], v[112:113], v[24:25]
    v_pk_mul_f32 v[114:115], v[114:115], v[26:27]
    v_pk_mul_f32 v[116:117], v[116:117], v[28:29]
    v_pk_mul_f32 v[118:119], v[118:119], v[30:31]
    v_cvt_pk_bf16_f32 v44, v112, v113
    v_cvt_pk_bf16_f32 v45, v114, v115
    v_cvt_pk_bf16_f32 v46, v116, v117
    v_cvt_pk_bf16_f32 v47, v118, v119
    buffer_store_dwordx4 v[44:47], v15, s[36:39], s11 offen offset:1024 sc1
    s_cmp_ge_u32 s10, 86
    s_cbranch_scc1 Lg1_done
    v_pk_mul_f32 v[16:17], v[128:129], v[128:129]
    v_pk_mul_f32 v[18:19], v[130:131], v[130:131]
    v_pk_mul_f32 v[20:21], v[132:133], v[132:133]
    v_pk_mul_f32 v[22:23], v[134:135], v[134:135]
    v_pk_fma_f32 v[16:17], v[16:17], s[42:43], v[56:57]
    v_pk_fma_f32 v[18:19], v[18:19], s[42:43], v[56:57]
    v_pk_fma_f32 v[20:21], v[20:21], s[42:43], v[56:57]
    v_pk_fma_f32 v[22:23], v[22:23], s[42:43], v[56:57]
    v_pk_mul_f32 v[16:17], v[16:17], v[128:129]
    v_pk_mul_f32 v[18:19], v[18:19], v[130:131]
    v_pk_mul_f32 v[20:21], v[20:21], v[132:133]
    v_pk_mul_f32 v[22:23], v[22:23], v[134:135]
    v_exp_f32 v16, v16
    v_exp_f32 v17, v17
    v_exp_f32 v18, v18
    v_exp_f32 v19, v19
    v_exp_f32 v20, v20
    v_exp_f32 v21, v21
    v_exp_f32 v22, v22
    v_exp_f32 v23, v23
    v_pk_mul_f32 v[128:129], v[128:129], v[136:137]
    v_pk_mul_f32 v[130:131], v[130:131], v[138:139]
    v_pk_mul_f32 v[132:133], v[132:133], v[140:141]
    v_pk_mul_f32 v[134:135], v[134:135], v[142:143]
    v_pk_add_f32 v[16:17], v[16:17], v[58:59]
    v_pk_add_f32 v[18:19], v[18:19], v[58:59]
    v_pk_add_f32 v[20:21], v[20:21], v[58:59]
    v_pk_add_f32 v[22:23], v[22:23], v[58:59]
    v_rcp_f32 v16, v16
    v_rcp_f32 v17, v17
    v_rcp_f32 v18, v18
    v_rcp_f32 v19, v19
    v_rcp_f32 v20, v20
    v_rcp_f32 v21, v21
    v_rcp_f32 v22, v22
    v_rcp_f32 v23, v23
    v_pk_mul_f32 v[128:129], v[128:129], v[16:17]
    v_pk_mul_f32 v[130:131], v[130:131], v[18:19]
    v_pk_mul_f32 v[132:133], v[132:133], v[20:21]
    v_pk_mul_f32 v[134:135], v[134:135], v[22:23]
    v_cvt_pk_bf16_f32 v32, v128, v129
    v_cvt_pk_bf16_f32 v33, v130, v131
    v_cvt_pk_bf16_f32 v34, v132, v133
    v_cvt_pk_bf16_f32 v35, v134, v135
    buffer_store_dwordx4 v[32:35], v15, s[36:39], s9 offen offset:2048 sc1
    v_pk_mul_f32 v[24:25], v[144:145], v[144:145]
    v_pk_mul_f32 v[26:27], v[146:147], v[146:147]
    v_pk_mul_f32 v[28:29], v[148:149], v[148:149]
    v_pk_mul_f32 v[30:31], v[150:151], v[150:151]
    v_pk_fma_f32 v[24:25], v[24:25], s[42:43], v[56:57]
    v_pk_fma_f32 v[26:27], v[26:27], s[42:43], v[56:57]
    v_pk_fma_f32 v[28:29], v[28:29], s[42:43], v[56:57]
    v_pk_fma_f32 v[30:31], v[30:31], s[42:43], v[56:57]
    v_pk_mul_f32 v[24:25], v[24:25], v[144:145]
    v_pk_mul_f32 v[26:27], v[26:27], v[146:147]
    v_pk_mul_f32 v[28:29], v[28:29], v[148:149]
    v_pk_mul_f32 v[30:31], v[30:31], v[150:151]
    v_exp_f32 v24, v24
    v_exp_f32 v25, v25
    v_exp_f32 v26, v26
    v_exp_f32 v27, v27
    v_exp_f32 v28, v28
    v_exp_f32 v29, v29
    v_exp_f32 v30, v30
    v_exp_f32 v31, v31
    v_pk_mul_f32 v[144:145], v[144:145], v[152:153]
    v_pk_mul_f32 v[146:147], v[146:147], v[154:155]
    v_pk_mul_f32 v[148:149], v[148:149], v[156:157]
    v_pk_mul_f32 v[150:151], v[150:151], v[158:159]
    v_pk_add_f32 v[24:25], v[24:25], v[58:59]
    v_pk_add_f32 v[26:27], v[26:27], v[58:59]
    v_pk_add_f32 v[28:29], v[28:29], v[58:59]
    v_pk_add_f32 v[30:31], v[30:31], v[58:59]
    v_rcp_f32 v24, v24
    v_rcp_f32 v25, v25
    v_rcp_f32 v26, v26
    v_rcp_f32 v27, v27
    v_rcp_f32 v28, v28
    v_rcp_f32 v29, v29
    v_rcp_f32 v30, v30
    v_rcp_f32 v31, v31
    v_pk_mul_f32 v[144:145], v[144:145], v[24:25]
    v_pk_mul_f32 v[146:147], v[146:147], v[26:27]
    v_pk_mul_f32 v[148:149], v[148:149], v[28:29]
    v_pk_mul_f32 v[150:151], v[150:151], v[30:31]
    v_cvt_pk_bf16_f32 v36, v144, v145
    v_cvt_pk_bf16_f32 v37, v146, v147
    v_cvt_pk_bf16_f32 v38, v148, v149
    v_cvt_pk_bf16_f32 v39, v150, v151
    buffer_store_dwordx4 v[36:39], v15, s[36:39], s11 offen offset:2048 sc1
Lg1_done:
    s_lshl_b32 s9, s5, 4
    s_add_u32 s9, s9, s6
    s_lshl_b32 s9, s9, 3
    s_add_u32 s9, s9, 13551616
    s_waitcnt vmcnt(0)
    s_barrier
    s_cmp_lg_u32 s3, 0
    s_cbranch_scc1 Lg1_end
    s_mov_b32 s62, 1048576
Ltag_g1:
    v_readfirstlane_b32 s60, v160
    v_readfirstlane_b32 s61, v161
    s_sub_u32 s62, s62, 1
    s_cbranch_scc1 Ltag_g1_ok
    s_cmp_lg_u32 s60, 0
    s_cbranch_scc1 Ltag_g1_ok
    s_sleep 2
    global_load_dwordx2 v[160:161], v162, s[24:25] sc1
    s_waitcnt vmcnt(0)
    s_branch Ltag_g1
Ltag_g1_ok:
    s_mov_b64 exec, 1
    buffer_store_dwordx2 v[160:161], v162, s[36:39], s9 offen sc1
    s_lshl_b32 s9, s2, 7
    s_add_u32 s9, s9, 13484032
    buffer_store_dword v160, v162, s[36:39], s9 offen sc1
Lg1_end:
    s_endpgm
Lk1_x:
    s_cmp_ge_u32 s2, 512
    s_cbranch_scc1 Lk1_y
    s_load_dwordx2 s[16:17], s[0:1], 0
    s_load_dwordx4 s[32:35], s[0:1], 96
    s_load_dwordx4 s[36:39], s[0:1], 120
    v_lshrrev_b32 v1, 6, v0
    v_and_b32 v2, 63, v0
    v_readfirstlane_b32 s3, v1
    s_sub_u32 s4, s2, 496
    s_lshl_b32 s4, s4, 2
    s_add_u32 s4, s4, s3
    v_lshlrev_b32 v10, 4, v2
    v_mov_b32 v23, 0
    s_mov_b32 s54, 0xffff0000
    s_waitcnt lgkmcnt(0)
    s_mov_b32 s48, s38
    s_mov_b32 s49, s39
    s_mov_b32 s50, 0xd70000
    s_mov_b32 s51, 0x00020000
    s_lshl_b32 s13, s4, 15
    v_lshlrev_b32 v11, 7, v2
    v_add_u32 v12, s13, v11
    v_add_u32 v11, s13, v10
    global_load_dwordx4 v[48:51], v10, s[34:35]
    global_load_dword v26, v12, s[16:17]
    v_add_u32 v12, 0x2000, v12
    global_load_dword v27, v12, s[16:17]
    v_add_u32 v12, 0x2000, v12
    global_load_dword v28, v12, s[16:17]
    v_add_u32 v12, 0x2000, v12
    global_load_dword v29, v12, s[16:17]
    v_add_u32 v12, 0x2000, v12
    global_load_dwordx4 v[80:83], v11, s[16:17] offset:0
    global_load_dwordx4 v[84:87], v11, s[16:17] offset:1024
    global_load_dwordx4 v[88:91], v11, s[16:17] offset:2048
    global_load_dwordx4 v[92:95], v11, s[16:17] offset:3072
    s_waitcnt vmcnt(0)
    v_lshlrev_b32 v52, 16, v48
    v_and_b32 v53, s54, v48
    v_lshlrev_b32 v54, 16, v49
    v_and_b32 v55, s54, v49
    v_lshlrev_b32 v56, 16, v50
    v_and_b32 v57, s54, v50
    v_lshlrev_b32 v58, 16, v51
    v_and_b32 v59, s54, v51
    s_lshl_b32 s15, s4, 7
    s_add_u32 s15, s15, 13500416
    s_mov_b64 s[20:21], 0x1111
    v_mov_b32 v21, 0
    s_mov_b32 s18, 8
Lc_loop:
    s_waitcnt vmcnt(0)
    v_mov_b32 v64, v80
    v_mov_b32 v65, v81
    v_mov_b32 v66, v82
    v_mov_b32 v67, v83
    v_mov_b32 v68, v84
    v_mov_b32 v69, v85
    v_mov_b32 v70, v86
    v_mov_b32 v71, v87
    v_mov_b32 v72, v88
    v_mov_b32 v73, v89
    v_mov_b32 v74, v90
    v_mov_b32 v75, v91
    v_mov_b32 v76, v92
    v_mov_b32 v77, v93
    v_mov_b32 v78, v94
    v_mov_b32 v79, v95
    v_add_u32 v11, 0x1000, v11
    s_cmp_eq_u32 s18, 1
    s_cbranch_scc1 Lc_nold
    global_load_dwordx4 v[80:83], v11, s[16:17] offset:0
    global_load_dwordx4 v[84:87], v11, s[16:17] offset:1024
    global_load_dwordx4 v[88:91], v11, s[16:17] offset:2048
    global_load_dwordx4 v[92:95], v11, s[16:17] offset:3072
Lc_nold:
    v_mov_b32 v32, 0
    v_mov_b32 v33, 0
    v_mov_b32 v34, 0
    v_mov_b32 v35, 0
    v_lshlrev_b32 v36, 16, v64
    v_and_b32 v37, s54, v64
    v_lshlrev_b32 v38, 16, v68
    v_and_b32 v39, s54, v68
    v_lshlrev_b32 v40, 16, v72
    v_and_b32 v41, s54, v72
    v_lshlrev_b32 v42, 16, v76
    v_and_b32 v43, s54, v76
    v_pk_mul_f32 v[36:37], v[36:37], v[52:53]
    v_pk_mul_f32 v[38:39], v[38:39], v[52:53]
    v_pk_mul_f32 v[40:41], v[40:41], v[52:53]
    v_pk_mul_f32 v[42:43], v[42:43], v[52:53]
    v_cvt_pk_bf16_f32 v36, v36, v37
    v_cvt_pk_bf16_f32 v38, v38, v39
    v_cvt_pk_bf16_f32 v40, v40, v41
    v_cvt_pk_bf16_f32 v42, v42, v43
    v_and_b32 v37, s54, v36
    v_lshlrev_b32 v36, 16, v36
    v_and_b32 v39, s54, v38
    v_lshlrev_b32 v38, 16, v38
    v_and_b32 v41, s54, v40
    v_lshlrev_b32 v40, 16, v40
    v_and_b32 v43, s54, v42
    v_lshlrev_b32 v42, 16, v42
    v_add_f32 v32, v32, v37
    v_add_f32 v33, v33, v39
    v_add_f32 v34, v34, v41
    v_add_f32 v35, v35, v43
    v_add_f32 v32, v32, v36
    v_add_f32 v33, v33, v38
    v_add_f32 v34, v34, v40
    v_add_f32 v35, v35, v42
    v_lshlrev_b32 v36, 16, v65
    v_and_b32 v37, s54, v65
    v_lshlrev_b32 v38, 16, v69
    v_and_b32 v39, s54, v69
    v_lshlrev_b32 v40, 16, v73
    v_and_b32 v41, s54, v73
    v_lshlrev_b32 v42, 16, v77
    v_and_b32 v43, s54, v77
    v_pk_mul_f32 v[36:37], v[36:37], v[54:55]
    v_pk_mul_f32 v[38:39], v[38:39], v[54:55]
    v_pk_mul_f32 v[40:41], v[40:41], v[54:55]
    v_pk_mul_f32 v[42:43], v[42:43], v[54:55]
    v_cvt_pk_bf16_f32 v36, v36, v37
    v_cvt_pk_bf16_f32 v38, v38, v39
    v_cvt_pk_bf16_f32 v40, v40, v41
    v_cvt_pk_bf16_f32 v42, v42, v43
    v_and_b32 v37, s54, v36
    v_lshlrev_b32 v36, 16, v36
    v_and_b32 v39, s54, v38
    v_lshlrev_b32 v38, 16, v38
    v_and_b32 v41, s54, v40
    v_lshlrev_b32 v40, 16, v40
    v_and_b32 v43, s54, v42
    v_lshlrev_b32 v42, 16, v42
    v_add_f32 v32, v32, v37
    v_add_f32 v33, v33, v39
    v_add_f32 v34, v34, v41
    v_add_f32 v35, v35, v43
    v_add_f32 v32, v32, v36
    v_add_f32 v33, v33, v38
    v_add_f32 v34, v34, v40
    v_add_f32 v35, v35, v42
    v_lshlrev_b32 v36, 16, v66
    v_and_b32 v37, s54, v66
    v_lshlrev_b32 v38, 16, v70
    v_and_b32 v39, s54, v70
    v_lshlrev_b32 v40, 16, v74
    v_and_b32 v41, s54, v74
    v_lshlrev_b32 v42, 16, v78
    v_and_b32 v43, s54, v78
    v_pk_mul_f32 v[36:37], v[36:37], v[56:57]
    v_pk_mul_f32 v[38:39], v[38:39], v[56:57]
    v_pk_mul_f32 v[40:41], v[40:41], v[56:57]
    v_pk_mul_f32 v[42:43], v[42:43], v[56:57]
    v_cvt_pk_bf16_f32 v36, v36, v37
    v_cvt_pk_bf16_f32 v38, v38, v39
    v_cvt_pk_bf16_f32 v40, v40, v41
    v_cvt_pk_bf16_f32 v42, v42, v43
    v_and_b32 v37, s54, v36
    v_lshlrev_b32 v36, 16, v36
    v_and_b32 v39, s54, v38
    v_lshlrev_b32 v38, 16, v38
    v_and_b32 v41, s54, v40
    v_lshlrev_b32 v40, 16, v40
    v_and_b32 v43, s54, v42
    v_lshlrev_b32 v42, 16, v42
    v_add_f32 v32, v32, v37
    v_add_f32 v33, v33, v39
    v_add_f32 v34, v34, v41
    v_add_f32 v35, v35, v43
    v_add_f32 v32, v32, v36
    v_add_f32 v33, v33, v38
    v_add_f32 v34, v34, v40
    v_add_f32 v35, v35, v42
    v_lshlrev_b32 v36, 16, v67
    v_and_b32 v37, s54, v67
    v_lshlrev_b32 v38, 16, v71
    v_and_b32 v39, s54, v71
    v_lshlrev_b32 v40, 16, v75
    v_and_b32 v41, s54, v75
    v_lshlrev_b32 v42, 16, v79
    v_and_b32 v43, s54, v79
    v_pk_mul_f32 v[36:37], v[36:37], v[58:59]
    v_pk_mul_f32 v[38:39], v[38:39], v[58:59]
    v_pk_mul_f32 v[40:41], v[40:41], v[58:59]
    v_pk_mul_f32 v[42:43], v[42:43], v[58:59]
    v_cvt_pk_bf16_f32 v36, v36, v37
    v_cvt_pk_bf16_f32 v38, v38, v39
    v_cvt_pk_bf16_f32 v40, v40, v41
    v_cvt_pk_bf16_f32 v42, v42, v43
    v_and_b32 v37, s54, v36
    v_lshlrev_b32 v36, 16, v36
    v_and_b32 v39, s54, v38
    v_lshlrev_b32 v38, 16, v38
    v_and_b32 v41, s54, v40
    v_lshlrev_b32 v40, 16, v40
    v_and_b32 v43, s54, v42
    v_lshlrev_b32 v42, 16, v42
    v_add_f32 v32, v32, v37
    v_add_f32 v33, v33, v39
    v_add_f32 v34, v34, v41
    v_add_f32 v35, v35, v43
    v_add_f32 v32, v32, v36
    v_add_f32 v33, v33, v38
    v_add_f32 v34, v34, v40
    v_add_f32 v35, v35, v42
    v_add_f32_dpp v32, v32, v32 row_ror:8 row_mask:0xf bank_mask:0xf
    v_add_f32_dpp v33, v33, v33 row_ror:8 row_mask:0xf bank_mask:0xf
    v_add_f32_dpp v34, v34, v34 row_ror:8 row_mask:0xf bank_mask:0xf
    v_add_f32_dpp v35, v35, v35 row_ror:8 row_mask:0xf bank_mask:0xf
    v_add_f32_dpp v32, v32, v32 row_ror:4 row_mask:0xf bank_mask:0xf
    v_add_f32_dpp v33, v33, v33 row_ror:4 row_mask:0xf bank_mask:0xf
    v_add_f32_dpp v34, v34, v34 row_ror:4 row_mask:0xf bank_mask:0xf
    v_add_f32_dpp v35, v35, v35 row_ror:4 row_mask:0xf bank_mask:0xf
    v_add_f32_dpp v32, v32, v32 row_ror:2 row_mask:0xf bank_mask:0xf
    v_add_f32_dpp v33, v33, v33 row_ror:2 row_mask:0xf bank_mask:0xf
    v_add_f32_dpp v34, v34, v34 row_ror:2 row_mask:0xf bank_mask:0xf
    v_add_f32_dpp v35, v35, v35 row_ror:2 row_mask:0xf bank_mask:0xf
    v_add_f32_dpp v32, v32, v32 row_ror:1 row_mask:0xf bank_mask:0xf
    v_add_f32_dpp v33, v33, v33 row_ror:1 row_mask:0xf bank_mask:0xf
    v_add_f32_dpp v34, v34, v34 row_ror:1 row_mask:0xf bank_mask:0xf
    v_add_f32_dpp v35, v35, v35 row_ror:1 row_mask:0xf bank_mask:0xf
    v_mov_b32_dpp v32, v33 quad_perm:[0,1,2,3] row_mask:0xf bank_mask:0x2
    s_nop 1
    v_mov_b32_dpp v32, v34 quad_perm:[0,1,2,3] row_mask:0xf bank_mask:0x4
    s_nop 1
    v_mov_b32_dpp v32, v35 quad_perm:[0,1,2,3] row_mask:0xf bank_mask:0x8
    v_mov_b32 v33, v32
    s_nop 1
    v_permlane16_swap_b32 v32, v33
    v_add_f32 v32, v32, v33
    v_mov_b32 v33, v32
    s_nop 1
    v_permlane32_swap_b32 v32, v33
    s_mov_b64 exec, s[20:21]
    v_add_f32 v21, v32, v33
    s_mov_b64 exec, -1
    s_lshl_b64 s[20:21], s[20:21], 16
    s_cselect_b64 s[20:21], s[20:21], 0x2222
    s_sub_u32 s18, s18, 1
    s_cmp_lg_u32 s18, 0
    s_cbranch_scc1 Lc_loop
    v_and_b32 v20, 60, v2
    v_and_b32 v22, 1, v2
    v_lshl_add_u32 v20, v22, 6, v20
    v_cvt_pk_bf16_f32 v32, v21, v21
    v_lshlrev_b32 v32, 16, v32
    v_mul_f32 v32, 0xbfb8aa3b, v32
    v_exp_f32 v32, v32
    s_nop 0
    v_add_f32 v32, 1.0, v32
    v_rcp_f32 v32, v32
    s_nop 0
    v_cvt_pk_bf16_f32 v32, v32, v32
    v_lshlrev_b32 v32, 16, v32
    s_mov_b32 exec_lo, 0x33333333
    s_mov_b32 exec_hi, 0x33333333
    buffer_store_dword v32, v20, s[48:51], s15 offen sc1
    global_load_dwordx2 v[24:25], v23, s[36:37] sc1
    s_waitcnt vmcnt(0)
    s_mov_b32 s62, 1048576
Ltag_c:
    v_readfirstlane_b32 s60, v24
    v_readfirstlane_b32 s61, v25
    s_sub_u32 s62, s62, 1
    s_cbranch_scc1 Ltag_c_ok
    s_cmp_lg_u32 s60, 0
    s_cbranch_scc1 Ltag_c_ok
    s_sleep 2
    global_load_dwordx2 v[24:25], v23, s[36:37] sc1
    s_waitcnt vmcnt(0)
    s_branch Ltag_c
Ltag_c_ok:
    s_lshl_b32 s14, s4, 3
    s_add_u32 s14, s14, 13557760
    s_mov_b64 exec, 1
    buffer_store_dwordx2 v[24:25], v23, s[48:51], s14 offen sc1
    s_endpgm
Lk1_y:
    s_endpgm
.section .rodata,"a"
.p2align 6
.amdhsa_kernel k1_kernel
  .amdhsa_next_free_vgpr 256
  .amdhsa_next_free_sgpr 100
  .amdhsa_accum_offset 256
  .amdhsa_group_segment_fixed_size 0
  .amdhsa_kernarg_size 136
  .amdhsa_user_sgpr_count 2
  .amdhsa_user_sgpr_kernarg_segment_ptr 1
  .amdhsa_system_sgpr_workgroup_id_x 1
.end_amdhsa_kernel
```
